```python
import torch

def _softmax(x, axis=-1):
    return torch.softmax(x, dim=axis)
def _gelu(x):
    return torch.nn.functional.gelu(x, approximate="tanh")
def _silu(x):
    return torch.nn.functional.silu(x)
def _sigmoid(x):
    return torch.sigmoid(x)
def _layernorm(x, axis=-1, eps=1e-5):
    m = x.mean(dim=axis, keepdim=True)
    v = x.var(dim=axis, keepdim=True, unbiased=False)
    return (x - m) / torch.sqrt(v + eps)
def _scatter_add(tgt, idx, src, axis=0):
    return tgt.clone().index_add_(axis, idx, src)
def _segment_sum(src, seg, n):
    out = torch.zeros((n,) + src.shape[1:], dtype=src.dtype)
    return out.index_add_(0, seg, src)
def _pad(x, pw):
    flat = tuple(v for pair in reversed(pw) for v in pair)
    return torch.nn.functional.pad(x, flat)

kernel_name = 'gated_mix__mha_block_cached__dense_activation_silu__decode'

def setup_inputs():

    _w = (lambda a: (lambda t: t.to(torch.bfloat16) if t.is_floating_point() else t)(torch.as_tensor(a)))
    def _A_setup():
        B, Sq, D = 2, 1, 512
        H, Sk, Dh = 32, 8192, 128
        return {
            "x": _w((lambda *s: torch.randn(*s, dtype=torch.bfloat16) * 0.05)(B, Sq, D)),
            "k_cache": _w((lambda *s: torch.randn(*s, dtype=torch.bfloat16) * 3.2)(B, H, Sk, Dh)),
            "v_cache": _w((lambda *s: torch.randn(*s, dtype=torch.bfloat16) * 0.1)(B, H, Sk, Dh)),
            "wq": _w((lambda *s: torch.randn(*s, dtype=torch.bfloat16) * 3.2)(D, H * Dh) * (D ** -0.5)),
            "wo": _w((lambda *s: torch.randn(*s, dtype=torch.bfloat16) * 0.1)(H * Dh, D) * ((H * Dh) ** -0.5)),
        }
    _A_in = _A_setup()

    def _B_setup():
        B, S, D, F = 2, 1, 512, 1792
        return {
            "x": _w((lambda *s: torch.randn(*s, dtype=torch.bfloat16) * 0.05)(B, S, D)),
            "w1": _w((lambda *s: torch.randn(*s, dtype=torch.bfloat16) * 0.05)(D, F) * (D ** -0.5)),
            "w2": _w((lambda *s: torch.randn(*s, dtype=torch.bfloat16) * 0.05)(F, D) * (F ** -0.5)),
        }
    _B_in = _B_setup()

    return {
        "A_x": _A_in["x"],
        "A_k_cache": _A_in["k_cache"],
        "A_v_cache": _A_in["v_cache"],
        "A_wq": _A_in["wq"],
        "A_wo": _A_in["wo"],
        "B_x": _B_in["x"],
        "B_w1": _B_in["w1"],
        "B_w2": _B_in["w2"],
        "gate_w": _w((lambda *s: torch.randn(*s, dtype=torch.bfloat16) * 0.05)(512) * 16.0),
    }

def reference(A_x, A_k_cache, A_v_cache, A_wq, A_wo, B_x, B_w1, B_w2, gate_w):
    def _A_ref(x, k_cache, v_cache, wq, wo):
        B, Sq, D = x.shape
        H, Dh = 32, 128
        q = (lambda x, *d: x.permute(*d))((x @ wq).reshape(B, Sq, H, Dh), 0, 2, 1, 3)
        scores = torch.einsum("bhqd,bhkd->bhqk", q, k_cache) * (Dh ** -0.5)
        p = _softmax(scores, axis=-1)
        o = torch.einsum("bhqk,bhkd->bhqd", p, v_cache)
        return (lambda x, *d: x.permute(*d))(o, 0, 2, 1, 3).reshape(B, Sq, H * Dh) @ wo

    def _B_ref(x, w1, w2):
        h = torch.einsum("bsd,df->bsf", x, w1)
        h = _silu(h)
        out = torch.einsum("bsf,fd->bsd", h, w2)
        return out

    x = A_x
    g = _sigmoid((x * gate_w).sum(-1, keepdims=True))
    a = _A_ref(x, A_k_cache, A_v_cache, A_wq, A_wo)
    b = _B_ref(x, B_w1, B_w2)
    return g * a + (1 - g) * b
```

```asm
; @launch kernel=k1_kernel grid=(256,1,1) block=(768,1,1) lds=143616
; @launch kernel=k2_kernel grid=(32,1,1) block=(256,1,1) lds=2048
.amdgcn_target "amdgcn-amd-amdhsa--gfx950"
.text
.globl k1_kernel
.p2align 8
.type k1_kernel,@function
k1_kernel:
    s_cmp_ge_u32 s2, 256
    s_cbranch_scc1 K1_end
    s_load_dwordx16 s[16:31], s[0:1], 0
    s_load_dwordx4 s[44:47], s[0:1], 80
    v_lshrrev_b32 v1, 6, v0
    v_and_b32 v0, 63, v0
    v_readfirstlane_b32 s3, v1
    s_and_b32 s4, s2, 63
    s_lshr_b32 s5, s2, 6
    s_mov_b32 s34, 0xffff0000
    s_cmp_lt_u32 s3, 4
    s_cbranch_scc1 K1_aux
    s_sub_u32 s3, s3, 4
    s_lshl_b32 s6, s4, 21
    s_lshl_b32 s7, s5, 19
    s_lshl_b32 s35, s3, 12
    s_add_u32 s50, s7, s35
    v_lshlrev_b32 v1, 4, v0
    s_mov_b32 s51, 16
    s_mov_b32 s53, 0
    s_mov_b32 s41, 0x3e0293ee
    s_waitcnt lgkmcnt(0)
    s_add_u32 s8, s18, s6
    s_addc_u32 s9, s19, 0
    s_and_b32 s9, s9, 0xffff
    s_mov_b32 s10, 2097152
    s_mov_b32 s11, 0x00020000
    s_add_u32 s12, s20, s6
    s_addc_u32 s13, s21, 0
    s_and_b32 s13, s13, 0xffff
    s_mov_b32 s14, 2097152
    s_mov_b32 s15, 0x00020000
    s_cmp_lt_u32 s53, s51
    s_cselect_b32 s40, s50, 0x40000000
    s_add_u32 s50, s50, 32768
    s_add_u32 s53, s53, 1
    buffer_load_dwordx4 v[36:39], v1, s[8:11], s40 offen offset:0 nt
    buffer_load_dwordx4 v[40:43], v1, s[8:11], s40 offen offset:1024 nt
    buffer_load_dwordx4 v[44:47], v1, s[8:11], s40 offen offset:2048 nt
    buffer_load_dwordx4 v[48:51], v1, s[8:11], s40 offen offset:3072 nt
    buffer_load_dwordx4 v[52:55], v1, s[12:15], s40 offen offset:0 nt
    buffer_load_dwordx4 v[56:59], v1, s[12:15], s40 offen offset:1024 nt
    buffer_load_dwordx4 v[60:63], v1, s[12:15], s40 offen offset:2048 nt
    buffer_load_dwordx4 v[64:67], v1, s[12:15], s40 offen offset:3072 nt
    s_waitcnt vmcnt(4)
    s_cmp_lt_u32 s53, s51
    s_cselect_b32 s40, s50, 0x40000000
    s_add_u32 s50, s50, 32768
    s_add_u32 s53, s53, 1
    buffer_load_dwordx4 v[68:71], v1, s[8:11], s40 offen offset:0 nt
    buffer_load_dwordx4 v[72:75], v1, s[8:11], s40 offen offset:1024 nt
    buffer_load_dwordx4 v[76:79], v1, s[8:11], s40 offen offset:2048 nt
    buffer_load_dwordx4 v[80:83], v1, s[8:11], s40 offen offset:3072 nt
    s_waitcnt vmcnt(4)
    buffer_load_dwordx4 v[84:87], v1, s[12:15], s40 offen offset:0 nt
    buffer_load_dwordx4 v[88:91], v1, s[12:15], s40 offen offset:1024 nt
    buffer_load_dwordx4 v[92:95], v1, s[12:15], s40 offen offset:2048 nt
    buffer_load_dwordx4 v[96:99], v1, s[12:15], s40 offen offset:3072 nt
    s_waitcnt vmcnt(4)
    s_cmp_lt_u32 s53, s51
    s_cselect_b32 s40, s50, 0x40000000
    s_add_u32 s50, s50, 32768
    s_add_u32 s53, s53, 1
    buffer_load_dwordx4 v[100:103], v1, s[8:11], s40 offen offset:0 nt
    buffer_load_dwordx4 v[104:107], v1, s[8:11], s40 offen offset:1024 nt
    buffer_load_dwordx4 v[108:111], v1, s[8:11], s40 offen offset:2048 nt
    buffer_load_dwordx4 v[112:115], v1, s[8:11], s40 offen offset:3072 nt
    s_waitcnt vmcnt(4)
    buffer_load_dwordx4 v[116:119], v1, s[12:15], s40 offen offset:0 nt
    buffer_load_dwordx4 v[120:123], v1, s[12:15], s40 offen offset:1024 nt
    buffer_load_dwordx4 v[124:127], v1, s[12:15], s40 offen offset:2048 nt
    buffer_load_dwordx4 v[128:131], v1, s[12:15], s40 offen offset:3072 nt
    s_waitcnt vmcnt(4)
    s_cmp_lt_u32 s53, s51
    s_cselect_b32 s40, s50, 0x40000000
    s_add_u32 s50, s50, 32768
    s_add_u32 s53, s53, 1
    buffer_load_dwordx4 v[132:135], v1, s[8:11], s40 offen offset:0 nt
    buffer_load_dwordx4 v[136:139], v1, s[8:11], s40 offen offset:1024 nt
    buffer_load_dwordx4 v[140:143], v1, s[8:11], s40 offen offset:2048 nt
    buffer_load_dwordx4 v[144:147], v1, s[8:11], s40 offen offset:3072 nt
    s_waitcnt vmcnt(4)
    buffer_load_dwordx4 v[148:151], v1, s[12:15], s40 offen offset:0 nt
    buffer_load_dwordx4 v[152:155], v1, s[12:15], s40 offen offset:1024 nt
    buffer_load_dwordx4 v[156:159], v1, s[12:15], s40 offen offset:2048 nt
    buffer_load_dwordx4 v[160:163], v1, s[12:15], s40 offen offset:3072 nt
    v_lshlrev_b32 v14, 5, v0
    v_and_b32 v14, 0x1e0, v14
    s_barrier
    ds_read_b128 v[16:19], v14 offset:0
    ds_read_b128 v[20:23], v14 offset:16
    ds_read_b128 v[24:27], v14 offset:512
    ds_read_b128 v[28:31], v14 offset:528
    s_waitcnt lgkmcnt(0)
    v_add_f32 v16, v16, v24
    v_add_f32 v17, v17, v25
    v_add_f32 v18, v18, v26
    v_add_f32 v19, v19, v27
    v_add_f32 v20, v20, v28
    v_add_f32 v21, v21, v29
    v_add_f32 v22, v22, v30
    v_add_f32 v23, v23, v31
    v_mov_b32 v6, v16
    v_mov_b32 v7, v17
    v_mov_b32 v8, v18
    v_mov_b32 v9, v19
    v_mov_b32 v10, v20
    v_mov_b32 v11, v21
    v_mov_b32 v12, v22
    v_mov_b32 v13, v23
    ds_read_b128 v[16:19], v14 offset:1024
    ds_read_b128 v[20:23], v14 offset:1040
    ds_read_b128 v[24:27], v14 offset:1536
    ds_read_b128 v[28:31], v14 offset:1552
    s_waitcnt lgkmcnt(0)
    v_add_f32 v16, v16, v24
    v_add_f32 v17, v17, v25
    v_add_f32 v18, v18, v26
    v_add_f32 v19, v19, v27
    v_add_f32 v20, v20, v28
    v_add_f32 v21, v21, v29
    v_add_f32 v22, v22, v30
    v_add_f32 v23, v23, v31
    v_add_f32 v16, v16, v6
    v_add_f32 v17, v17, v7
    v_add_f32 v18, v18, v8
    v_add_f32 v19, v19, v9
    v_add_f32 v20, v20, v10
    v_add_f32 v21, v21, v11
    v_add_f32 v22, v22, v12
    v_add_f32 v23, v23, v13
    v_cvt_pk_bf16_f32 v2, v16, v17
    v_cvt_pk_bf16_f32 v3, v18, v19
    v_cvt_pk_bf16_f32 v4, v20, v21
    v_cvt_pk_bf16_f32 v5, v22, v23
    v_mov_b32 v6, 0
    v_mov_b32 v7, 0
    v_mov_b32 v8, 0
    v_mov_b32 v9, 0
    v_mov_b32 v10, 0
    v_mov_b32 v11, 0
    v_mov_b32 v12, 0
    v_mov_b32 v13, 0
    v_mov_b32 v165, 0
    v_mov_b32 v166, 1
    v_mov_b32 v14, 0xff7fffff
    v_mov_b32 v15, 0
    s_waitcnt vmcnt(28)
    v_dot2_f32_bf16 v16, v36, v2, 0
    v_dot2_f32_bf16 v17, v40, v2, 0
    v_dot2_f32_bf16 v18, v44, v2, 0
    v_dot2_f32_bf16 v19, v48, v2, 0
    v_dot2_f32_bf16 v16, v37, v3, v16
    v_dot2_f32_bf16 v17, v41, v3, v17
    v_dot2_f32_bf16 v18, v45, v3, v18
    v_dot2_f32_bf16 v19, v49, v3, v19
    v_dot2_f32_bf16 v16, v38, v4, v16
    v_dot2_f32_bf16 v17, v42, v4, v17
    v_dot2_f32_bf16 v18, v46, v4, v18
    v_dot2_f32_bf16 v19, v50, v4, v19
    v_dot2_f32_bf16 v16, v39, v5, v16
    v_dot2_f32_bf16 v17, v43, v5, v17
    v_dot2_f32_bf16 v18, v47, v5, v18
    v_dot2_f32_bf16 v19, v51, v5, v19
    s_nop 2
    v_add_f32_dpp v16, v16, v16 quad_perm:[1,0,3,2] row_mask:0xf bank_mask:0xf
    v_add_f32_dpp v17, v17, v17 quad_perm:[1,0,3,2] row_mask:0xf bank_mask:0xf
    v_add_f32_dpp v18, v18, v18 quad_perm:[1,0,3,2] row_mask:0xf bank_mask:0xf
    v_add_f32_dpp v19, v19, v19 quad_perm:[1,0,3,2] row_mask:0xf bank_mask:0xf
    v_add_f32_dpp v16, v16, v16 quad_perm:[2,3,0,1] row_mask:0xf bank_mask:0xf
    v_add_f32_dpp v17, v17, v17 quad_perm:[2,3,0,1] row_mask:0xf bank_mask:0xf
    v_add_f32_dpp v18, v18, v18 quad_perm:[2,3,0,1] row_mask:0xf bank_mask:0xf
    v_add_f32_dpp v19, v19, v19 quad_perm:[2,3,0,1] row_mask:0xf bank_mask:0xf
    v_add_f32_dpp v16, v16, v16 row_half_mirror row_mask:0xf bank_mask:0xf
    v_add_f32_dpp v17, v17, v17 row_half_mirror row_mask:0xf bank_mask:0xf
    v_add_f32_dpp v18, v18, v18 row_half_mirror row_mask:0xf bank_mask:0xf
    v_add_f32_dpp v19, v19, v19 row_half_mirror row_mask:0xf bank_mask:0xf
    v_add_f32_dpp v16, v16, v16 row_mirror row_mask:0xf bank_mask:0xf
    v_add_f32_dpp v17, v17, v17 row_mirror row_mask:0xf bank_mask:0xf
    v_add_f32_dpp v18, v18, v18 row_mirror row_mask:0xf bank_mask:0xf
    v_add_f32_dpp v19, v19, v19 row_mirror row_mask:0xf bank_mask:0xf
    v_max3_f32 v20, v14, v16, v17
    v_max3_f32 v20, v20, v18, v19
    v_sub_f32 v21, v14, v20
    v_mul_f32 v22, s41, v20
    v_mul_f32 v21, s41, v21
    v_fma_f32 v16, v16, s41, -v22
    v_fma_f32 v17, v17, s41, -v22
    v_fma_f32 v18, v18, s41, -v22
    v_fma_f32 v19, v19, s41, -v22
    v_exp_f32 v21, v21
    v_exp_f32 v16, v16
    v_exp_f32 v17, v17
    v_exp_f32 v18, v18
    v_exp_f32 v19, v19
    v_mov_b32 v14, v20
    v_mul_f32 v6, v6, v21
    v_mul_f32 v7, v7, v21
    v_mul_f32 v8, v8, v21
    v_mul_f32 v9, v9, v21
    v_mul_f32 v10, v10, v21
    v_mul_f32 v11, v11, v21
    v_mul_f32 v12, v12, v21
    v_mul_f32 v13, v13, v21
    v_fma_f32 v15, v15, v21, v16
    v_add_f32 v22, v17, v18
    v_add_f32 v15, v15, v19
    v_add_f32 v15, v15, v22
    s_waitcnt vmcnt(24)
    v_lshlrev_b32 v20, 16, v52
    v_and_b32 v21, s34, v52
    v_lshlrev_b32 v22, 16, v53
    v_and_b32 v23, s34, v53
    v_lshlrev_b32 v24, 16, v54
    v_and_b32 v25, s34, v54
    v_lshlrev_b32 v26, 16, v55
    v_and_b32 v27, s34, v55
    v_fmac_f32 v6, v16, v20
    v_fmac_f32 v7, v16, v21
    v_fmac_f32 v8, v16, v22
    v_fmac_f32 v9, v16, v23
    v_fmac_f32 v10, v16, v24
    v_fmac_f32 v11, v16, v25
    v_fmac_f32 v12, v16, v26
    v_fmac_f32 v13, v16, v27
    v_lshlrev_b32 v28, 16, v56
    v_and_b32 v29, s34, v56
    v_lshlrev_b32 v30, 16, v57
    v_and_b32 v31, s34, v57
    v_lshlrev_b32 v32, 16, v58
    v_and_b32 v33, s34, v58
    v_lshlrev_b32 v34, 16, v59
    v_and_b32 v35, s34, v59
    v_fmac_f32 v6, v17, v28
    v_fmac_f32 v7, v17, v29
    v_fmac_f32 v8, v17, v30
    v_fmac_f32 v9, v17, v31
    v_fmac_f32 v10, v17, v32
    v_fmac_f32 v11, v17, v33
    v_fmac_f32 v12, v17, v34
    v_fmac_f32 v13, v17, v35
    v_lshlrev_b32 v20, 16, v60
    v_and_b32 v21, s34, v60
    v_lshlrev_b32 v22, 16, v61
    v_and_b32 v23, s34, v61
    v_lshlrev_b32 v24, 16, v62
    v_and_b32 v25, s34, v62
    v_lshlrev_b32 v26, 16, v63
    v_and_b32 v27, s34, v63
    v_fmac_f32 v6, v18, v20
    v_fmac_f32 v7, v18, v21
    v_fmac_f32 v8, v18, v22
    v_fmac_f32 v9, v18, v23
    v_fmac_f32 v10, v18, v24
    v_fmac_f32 v11, v18, v25
    v_fmac_f32 v12, v18, v26
    v_fmac_f32 v13, v18, v27
    v_lshlrev_b32 v28, 16, v64
    v_and_b32 v29, s34, v64
    v_lshlrev_b32 v30, 16, v65
    v_and_b32 v31, s34, v65
    v_lshlrev_b32 v32, 16, v66
    v_and_b32 v33, s34, v66
    v_lshlrev_b32 v34, 16, v67
    v_and_b32 v35, s34, v67
    v_fmac_f32 v6, v19, v28
    v_fmac_f32 v7, v19, v29
    v_fmac_f32 v8, v19, v30
    v_fmac_f32 v9, v19, v31
    v_fmac_f32 v10, v19, v32
    v_fmac_f32 v11, v19, v33
    v_fmac_f32 v12, v19, v34
    v_fmac_f32 v13, v19, v35
    s_cmp_lt_u32 s53, s51
    s_cselect_b32 s40, s50, 0x40000000
    s_add_u32 s50, s50, 32768
    s_add_u32 s53, s53, 1
    buffer_load_dwordx4 v[36:39], v1, s[8:11], s40 offen offset:0 nt
    buffer_load_dwordx4 v[40:43], v1, s[8:11], s40 offen offset:1024 nt
    buffer_load_dwordx4 v[44:47], v1, s[8:11], s40 offen offset:2048 nt
    buffer_load_dwordx4 v[48:51], v1, s[8:11], s40 offen offset:3072 nt
    buffer_load_dwordx4 v[52:55], v1, s[12:15], s40 offen offset:0 nt
    buffer_load_dwordx4 v[56:59], v1, s[12:15], s40 offen offset:1024 nt
    buffer_load_dwordx4 v[60:63], v1, s[12:15], s40 offen offset:2048 nt
    buffer_load_dwordx4 v[64:67], v1, s[12:15], s40 offen offset:3072 nt
    s_mov_b64 exec, 1
    ds_add_u32 v165, v166 offset:8260
    s_mov_b64 exec, -1
    s_waitcnt vmcnt(28)
    v_dot2_f32_bf16 v16, v68, v2, 0
    v_dot2_f32_bf16 v17, v72, v2, 0
    v_dot2_f32_bf16 v18, v76, v2, 0
    v_dot2_f32_bf16 v19, v80, v2, 0
    v_dot2_f32_bf16 v16, v69, v3, v16
    v_dot2_f32_bf16 v17, v73, v3, v17
    v_dot2_f32_bf16 v18, v77, v3, v18
    v_dot2_f32_bf16 v19, v81, v3, v19
    v_dot2_f32_bf16 v16, v70, v4, v16
    v_dot2_f32_bf16 v17, v74, v4, v17
    v_dot2_f32_bf16 v18, v78, v4, v18
    v_dot2_f32_bf16 v19, v82, v4, v19
    v_dot2_f32_bf16 v16, v71, v5, v16
    v_dot2_f32_bf16 v17, v75, v5, v17
    v_dot2_f32_bf16 v18, v79, v5, v18
    v_dot2_f32_bf16 v19, v83, v5, v19
    s_nop 2
    v_add_f32_dpp v16, v16, v16 quad_perm:[1,0,3,2] row_mask:0xf bank_mask:0xf
    v_add_f32_dpp v17, v17, v17 quad_perm:[1,0,3,2] row_mask:0xf bank_mask:0xf
    v_add_f32_dpp v18, v18, v18 quad_perm:[1,0,3,2] row_mask:0xf bank_mask:0xf
    v_add_f32_dpp v19, v19, v19 quad_perm:[1,0,3,2] row_mask:0xf bank_mask:0xf
    v_add_f32_dpp v16, v16, v16 quad_perm:[2,3,0,1] row_mask:0xf bank_mask:0xf
    v_add_f32_dpp v17, v17, v17 quad_perm:[2,3,0,1] row_mask:0xf bank_mask:0xf
    v_add_f32_dpp v18, v18, v18 quad_perm:[2,3,0,1] row_mask:0xf bank_mask:0xf
    v_add_f32_dpp v19, v19, v19 quad_perm:[2,3,0,1] row_mask:0xf bank_mask:0xf
    v_add_f32_dpp v16, v16, v16 row_half_mirror row_mask:0xf bank_mask:0xf
    v_add_f32_dpp v17, v17, v17 row_half_mirror row_mask:0xf bank_mask:0xf
    v_add_f32_dpp v18, v18, v18 row_half_mirror row_mask:0xf bank_mask:0xf
    v_add_f32_dpp v19, v19, v19 row_half_mirror row_mask:0xf bank_mask:0xf
    v_add_f32_dpp v16, v16, v16 row_mirror row_mask:0xf bank_mask:0xf
    v_add_f32_dpp v17, v17, v17 row_mirror row_mask:0xf bank_mask:0xf
    v_add_f32_dpp v18, v18, v18 row_mirror row_mask:0xf bank_mask:0xf
    v_add_f32_dpp v19, v19, v19 row_mirror row_mask:0xf bank_mask:0xf
    v_max3_f32 v20, v14, v16, v17
    v_max3_f32 v20, v20, v18, v19
    v_sub_f32 v21, v14, v20
    v_mul_f32 v22, s41, v20
    v_mul_f32 v21, s41, v21
    v_fma_f32 v16, v16, s41, -v22
    v_fma_f32 v17, v17, s41, -v22
    v_fma_f32 v18, v18, s41, -v22
    v_fma_f32 v19, v19, s41, -v22
    v_exp_f32 v21, v21
    v_exp_f32 v16, v16
    v_exp_f32 v17, v17
    v_exp_f32 v18, v18
    v_exp_f32 v19, v19
    v_mov_b32 v14, v20
    v_mul_f32 v6, v6, v21
    v_mul_f32 v7, v7, v21
    v_mul_f32 v8, v8, v21
    v_mul_f32 v9, v9, v21
    v_mul_f32 v10, v10, v21
    v_mul_f32 v11, v11, v21
    v_mul_f32 v12, v12, v21
    v_mul_f32 v13, v13, v21
    v_fma_f32 v15, v15, v21, v16
    v_add_f32 v22, v17, v18
    v_add_f32 v15, v15, v19
    v_add_f32 v15, v15, v22
    s_waitcnt vmcnt(24)
    v_lshlrev_b32 v20, 16, v84
    v_and_b32 v21, s34, v84
    v_lshlrev_b32 v22, 16, v85
    v_and_b32 v23, s34, v85
    v_lshlrev_b32 v24, 16, v86
    v_and_b32 v25, s34, v86
    v_lshlrev_b32 v26, 16, v87
    v_and_b32 v27, s34, v87
    v_fmac_f32 v6, v16, v20
    v_fmac_f32 v7, v16, v21
    v_fmac_f32 v8, v16, v22
    v_fmac_f32 v9, v16, v23
    v_fmac_f32 v10, v16, v24
    v_fmac_f32 v11, v16, v25
    v_fmac_f32 v12, v16, v26
    v_fmac_f32 v13, v16, v27
    v_lshlrev_b32 v28, 16, v88
    v_and_b32 v29, s34, v88
    v_lshlrev_b32 v30, 16, v89
    v_and_b32 v31, s34, v89
    v_lshlrev_b32 v32, 16, v90
    v_and_b32 v33, s34, v90
    v_lshlrev_b32 v34, 16, v91
    v_and_b32 v35, s34, v91
    v_fmac_f32 v6, v17, v28
    v_fmac_f32 v7, v17, v29
    v_fmac_f32 v8, v17, v30
    v_fmac_f32 v9, v17, v31
    v_fmac_f32 v10, v17, v32
    v_fmac_f32 v11, v17, v33
    v_fmac_f32 v12, v17, v34
    v_fmac_f32 v13, v17, v35
    v_lshlrev_b32 v20, 16, v92
    v_and_b32 v21, s34, v92
    v_lshlrev_b32 v22, 16, v93
    v_and_b32 v23, s34, v93
    v_lshlrev_b32 v24, 16, v94
    v_and_b32 v25, s34, v94
    v_lshlrev_b32 v26, 16, v95
    v_and_b32 v27, s34, v95
    v_fmac_f32 v6, v18, v20
    v_fmac_f32 v7, v18, v21
    v_fmac_f32 v8, v18, v22
    v_fmac_f32 v9, v18, v23
    v_fmac_f32 v10, v18, v24
    v_fmac_f32 v11, v18, v25
    v_fmac_f32 v12, v18, v26
    v_fmac_f32 v13, v18, v27
    v_lshlrev_b32 v28, 16, v96
    v_and_b32 v29, s34, v96
    v_lshlrev_b32 v30, 16, v97
    v_and_b32 v31, s34, v97
    v_lshlrev_b32 v32, 16, v98
    v_and_b32 v33, s34, v98
    v_lshlrev_b32 v34, 16, v99
    v_and_b32 v35, s34, v99
    v_fmac_f32 v6, v19, v28
    v_fmac_f32 v7, v19, v29
    v_fmac_f32 v8, v19, v30
    v_fmac_f32 v9, v19, v31
    v_fmac_f32 v10, v19, v32
    v_fmac_f32 v11, v19, v33
    v_fmac_f32 v12, v19, v34
    v_fmac_f32 v13, v19, v35
    s_cmp_lt_u32 s53, s51
    s_cselect_b32 s40, s50, 0x40000000
    s_add_u32 s50, s50, 32768
    s_add_u32 s53, s53, 1
    buffer_load_dwordx4 v[68:71], v1, s[8:11], s40 offen offset:0 nt
    buffer_load_dwordx4 v[72:75], v1, s[8:11], s40 offen offset:1024 nt
    buffer_load_dwordx4 v[76:79], v1, s[8:11], s40 offen offset:2048 nt
    buffer_load_dwordx4 v[80:83], v1, s[8:11], s40 offen offset:3072 nt
    buffer_load_dwordx4 v[84:87], v1, s[12:15], s40 offen offset:0 nt
    buffer_load_dwordx4 v[88:91], v1, s[12:15], s40 offen offset:1024 nt
    buffer_load_dwordx4 v[92:95], v1, s[12:15], s40 offen offset:2048 nt
    buffer_load_dwordx4 v[96:99], v1, s[12:15], s40 offen offset:3072 nt
    s_mov_b64 exec, 1
    ds_add_u32 v165, v166 offset:8260
    s_mov_b64 exec, -1
    s_waitcnt vmcnt(28)
    v_dot2_f32_bf16 v16, v100, v2, 0
    v_dot2_f32_bf16 v17, v104, v2, 0
    v_dot2_f32_bf16 v18, v108, v2, 0
    v_dot2_f32_bf16 v19, v112, v2, 0
    v_dot2_f32_bf16 v16, v101, v3, v16
    v_dot2_f32_bf16 v17, v105, v3, v17
    v_dot2_f32_bf16 v18, v109, v3, v18
    v_dot2_f32_bf16 v19, v113, v3, v19
    v_dot2_f32_bf16 v16, v102, v4, v16
    v_dot2_f32_bf16 v17, v106, v4, v17
    v_dot2_f32_bf16 v18, v110, v4, v18
    v_dot2_f32_bf16 v19, v114, v4, v19
    v_dot2_f32_bf16 v16, v103, v5, v16
    v_dot2_f32_bf16 v17, v107, v5, v17
    v_dot2_f32_bf16 v18, v111, v5, v18
    v_dot2_f32_bf16 v19, v115, v5, v19
    s_nop 2
    v_add_f32_dpp v16, v16, v16 quad_perm:[1,0,3,2] row_mask:0xf bank_mask:0xf
    v_add_f32_dpp v17, v17, v17 quad_perm:[1,0,3,2] row_mask:0xf bank_mask:0xf
    v_add_f32_dpp v18, v18, v18 quad_perm:[1,0,3,2] row_mask:0xf bank_mask:0xf
    v_add_f32_dpp v19, v19, v19 quad_perm:[1,0,3,2] row_mask:0xf bank_mask:0xf
    v_add_f32_dpp v16, v16, v16 quad_perm:[2,3,0,1] row_mask:0xf bank_mask:0xf
    v_add_f32_dpp v17, v17, v17 quad_perm:[2,3,0,1] row_mask:0xf bank_mask:0xf
    v_add_f32_dpp v18, v18, v18 quad_perm:[2,3,0,1] row_mask:0xf bank_mask:0xf
    v_add_f32_dpp v19, v19, v19 quad_perm:[2,3,0,1] row_mask:0xf bank_mask:0xf
    v_add_f32_dpp v16, v16, v16 row_half_mirror row_mask:0xf bank_mask:0xf
    v_add_f32_dpp v17, v17, v17 row_half_mirror row_mask:0xf bank_mask:0xf
    v_add_f32_dpp v18, v18, v18 row_half_mirror row_mask:0xf bank_mask:0xf
    v_add_f32_dpp v19, v19, v19 row_half_mirror row_mask:0xf bank_mask:0xf
    v_add_f32_dpp v16, v16, v16 row_mirror row_mask:0xf bank_mask:0xf
    v_add_f32_dpp v17, v17, v17 row_mirror row_mask:0xf bank_mask:0xf
    v_add_f32_dpp v18, v18, v18 row_mirror row_mask:0xf bank_mask:0xf
    v_add_f32_dpp v19, v19, v19 row_mirror row_mask:0xf bank_mask:0xf
    v_max3_f32 v20, v14, v16, v17
    v_max3_f32 v20, v20, v18, v19
    v_sub_f32 v21, v14, v20
    v_mul_f32 v22, s41, v20
    v_mul_f32 v21, s41, v21
    v_fma_f32 v16, v16, s41, -v22
    v_fma_f32 v17, v17, s41, -v22
    v_fma_f32 v18, v18, s41, -v22
    v_fma_f32 v19, v19, s41, -v22
    v_exp_f32 v21, v21
    v_exp_f32 v16, v16
    v_exp_f32 v17, v17
    v_exp_f32 v18, v18
    v_exp_f32 v19, v19
    v_mov_b32 v14, v20
    v_mul_f32 v6, v6, v21
    v_mul_f32 v7, v7, v21
    v_mul_f32 v8, v8, v21
    v_mul_f32 v9, v9, v21
    v_mul_f32 v10, v10, v21
    v_mul_f32 v11, v11, v21
    v_mul_f32 v12, v12, v21
    v_mul_f32 v13, v13, v21
    v_fma_f32 v15, v15, v21, v16
    v_add_f32 v22, v17, v18
    v_add_f32 v15, v15, v19
    v_add_f32 v15, v15, v22
    s_waitcnt vmcnt(24)
    v_lshlrev_b32 v20, 16, v116
    v_and_b32 v21, s34, v116
    v_lshlrev_b32 v22, 16, v117
    v_and_b32 v23, s34, v117
    v_lshlrev_b32 v24, 16, v118
    v_and_b32 v25, s34, v118
    v_lshlrev_b32 v26, 16, v119
    v_and_b32 v27, s34, v119
    v_fmac_f32 v6, v16, v20
    v_fmac_f32 v7, v16, v21
    v_fmac_f32 v8, v16, v22
    v_fmac_f32 v9, v16, v23
    v_fmac_f32 v10, v16, v24
    v_fmac_f32 v11, v16, v25
    v_fmac_f32 v12, v16, v26
    v_fmac_f32 v13, v16, v27
    v_lshlrev_b32 v28, 16, v120
    v_and_b32 v29, s34, v120
    v_lshlrev_b32 v30, 16, v121
    v_and_b32 v31, s34, v121
    v_lshlrev_b32 v32, 16, v122
    v_and_b32 v33, s34, v122
    v_lshlrev_b32 v34, 16, v123
    v_and_b32 v35, s34, v123
    v_fmac_f32 v6, v17, v28
    v_fmac_f32 v7, v17, v29
    v_fmac_f32 v8, v17, v30
    v_fmac_f32 v9, v17, v31
    v_fmac_f32 v10, v17, v32
    v_fmac_f32 v11, v17, v33
    v_fmac_f32 v12, v17, v34
    v_fmac_f32 v13, v17, v35
    v_lshlrev_b32 v20, 16, v124
    v_and_b32 v21, s34, v124
    v_lshlrev_b32 v22, 16, v125
    v_and_b32 v23, s34, v125
    v_lshlrev_b32 v24, 16, v126
    v_and_b32 v25, s34, v126
    v_lshlrev_b32 v26, 16, v127
    v_and_b32 v27, s34, v127
    v_fmac_f32 v6, v18, v20
    v_fmac_f32 v7, v18, v21
    v_fmac_f32 v8, v18, v22
    v_fmac_f32 v9, v18, v23
    v_fmac_f32 v10, v18, v24
    v_fmac_f32 v11, v18, v25
    v_fmac_f32 v12, v18, v26
    v_fmac_f32 v13, v18, v27
    v_lshlrev_b32 v28, 16, v128
    v_and_b32 v29, s34, v128
    v_lshlrev_b32 v30, 16, v129
    v_and_b32 v31, s34, v129
    v_lshlrev_b32 v32, 16, v130
    v_and_b32 v33, s34, v130
    v_lshlrev_b32 v34, 16, v131
    v_and_b32 v35, s34, v131
    v_fmac_f32 v6, v19, v28
    v_fmac_f32 v7, v19, v29
    v_fmac_f32 v8, v19, v30
    v_fmac_f32 v9, v19, v31
    v_fmac_f32 v10, v19, v32
    v_fmac_f32 v11, v19, v33
    v_fmac_f32 v12, v19, v34
    v_fmac_f32 v13, v19, v35
    s_mov_b64 exec, 1
    ds_add_u32 v165, v166 offset:8260
    s_mov_b64 exec, -1
    s_waitcnt vmcnt(20)
    v_dot2_f32_bf16 v16, v132, v2, 0
    v_dot2_f32_bf16 v17, v136, v2, 0
    v_dot2_f32_bf16 v18, v140, v2, 0
    v_dot2_f32_bf16 v19, v144, v2, 0
    v_dot2_f32_bf16 v16, v133, v3, v16
    v_dot2_f32_bf16 v17, v137, v3, v17
    v_dot2_f32_bf16 v18, v141, v3, v18
    v_dot2_f32_bf16 v19, v145, v3, v19
    v_dot2_f32_bf16 v16, v134, v4, v16
    v_dot2_f32_bf16 v17, v138, v4, v17
    v_dot2_f32_bf16 v18, v142, v4, v18
    v_dot2_f32_bf16 v19, v146, v4, v19
    v_dot2_f32_bf16 v16, v135, v5, v16
    v_dot2_f32_bf16 v17, v139, v5, v17
    v_dot2_f32_bf16 v18, v143, v5, v18
    v_dot2_f32_bf16 v19, v147, v5, v19
    s_nop 2
    v_add_f32_dpp v16, v16, v16 quad_perm:[1,0,3,2] row_mask:0xf bank_mask:0xf
    v_add_f32_dpp v17, v17, v17 quad_perm:[1,0,3,2] row_mask:0xf bank_mask:0xf
    v_add_f32_dpp v18, v18, v18 quad_perm:[1,0,3,2] row_mask:0xf bank_mask:0xf
    v_add_f32_dpp v19, v19, v19 quad_perm:[1,0,3,2] row_mask:0xf bank_mask:0xf
    v_add_f32_dpp v16, v16, v16 quad_perm:[2,3,0,1] row_mask:0xf bank_mask:0xf
    v_add_f32_dpp v17, v17, v17 quad_perm:[2,3,0,1] row_mask:0xf bank_mask:0xf
    v_add_f32_dpp v18, v18, v18 quad_perm:[2,3,0,1] row_mask:0xf bank_mask:0xf
    v_add_f32_dpp v19, v19, v19 quad_perm:[2,3,0,1] row_mask:0xf bank_mask:0xf
    v_add_f32_dpp v16, v16, v16 row_half_mirror row_mask:0xf bank_mask:0xf
    v_add_f32_dpp v17, v17, v17 row_half_mirror row_mask:0xf bank_mask:0xf
    v_add_f32_dpp v18, v18, v18 row_half_mirror row_mask:0xf bank_mask:0xf
    v_add_f32_dpp v19, v19, v19 row_half_mirror row_mask:0xf bank_mask:0xf
    v_add_f32_dpp v16, v16, v16 row_mirror row_mask:0xf bank_mask:0xf
    v_add_f32_dpp v17, v17, v17 row_mirror row_mask:0xf bank_mask:0xf
    v_add_f32_dpp v18, v18, v18 row_mirror row_mask:0xf bank_mask:0xf
    v_add_f32_dpp v19, v19, v19 row_mirror row_mask:0xf bank_mask:0xf
    v_max3_f32 v20, v14, v16, v17
    v_max3_f32 v20, v20, v18, v19
    v_sub_f32 v21, v14, v20
    v_mul_f32 v22, s41, v20
    v_mul_f32 v21, s41, v21
    v_fma_f32 v16, v16, s41, -v22
    v_fma_f32 v17, v17, s41, -v22
    v_fma_f32 v18, v18, s41, -v22
    v_fma_f32 v19, v19, s41, -v22
    v_exp_f32 v21, v21
    v_exp_f32 v16, v16
    v_exp_f32 v17, v17
    v_exp_f32 v18, v18
    v_exp_f32 v19, v19
    v_mov_b32 v14, v20
    v_mul_f32 v6, v6, v21
    v_mul_f32 v7, v7, v21
    v_mul_f32 v8, v8, v21
    v_mul_f32 v9, v9, v21
    v_mul_f32 v10, v10, v21
    v_mul_f32 v11, v11, v21
    v_mul_f32 v12, v12, v21
    v_mul_f32 v13, v13, v21
    v_fma_f32 v15, v15, v21, v16
    v_add_f32 v22, v17, v18
    v_add_f32 v15, v15, v19
    v_add_f32 v15, v15, v22
    s_waitcnt vmcnt(16)
    v_lshlrev_b32 v20, 16, v148
    v_and_b32 v21, s34, v148
    v_lshlrev_b32 v22, 16, v149
    v_and_b32 v23, s34, v149
    v_lshlrev_b32 v24, 16, v150
    v_and_b32 v25, s34, v150
    v_lshlrev_b32 v26, 16, v151
    v_and_b32 v27, s34, v151
    v_fmac_f32 v6, v16, v20
    v_fmac_f32 v7, v16, v21
    v_fmac_f32 v8, v16, v22
    v_fmac_f32 v9, v16, v23
    v_fmac_f32 v10, v16, v24
    v_fmac_f32 v11, v16, v25
    v_fmac_f32 v12, v16, v26
    v_fmac_f32 v13, v16, v27
    v_lshlrev_b32 v28, 16, v152
    v_and_b32 v29, s34, v152
    v_lshlrev_b32 v30, 16, v153
    v_and_b32 v31, s34, v153
    v_lshlrev_b32 v32, 16, v154
    v_and_b32 v33, s34, v154
    v_lshlrev_b32 v34, 16, v155
    v_and_b32 v35, s34, v155
    v_fmac_f32 v6, v17, v28
    v_fmac_f32 v7, v17, v29
    v_fmac_f32 v8, v17, v30
    v_fmac_f32 v9, v17, v31
    v_fmac_f32 v10, v17, v32
    v_fmac_f32 v11, v17, v33
    v_fmac_f32 v12, v17, v34
    v_fmac_f32 v13, v17, v35
    v_lshlrev_b32 v20, 16, v156
    v_and_b32 v21, s34, v156
    v_lshlrev_b32 v22, 16, v157
    v_and_b32 v23, s34, v157
    v_lshlrev_b32 v24, 16, v158
    v_and_b32 v25, s34, v158
    v_lshlrev_b32 v26, 16, v159
    v_and_b32 v27, s34, v159
    v_fmac_f32 v6, v18, v20
    v_fmac_f32 v7, v18, v21
    v_fmac_f32 v8, v18, v22
    v_fmac_f32 v9, v18, v23
    v_fmac_f32 v10, v18, v24
    v_fmac_f32 v11, v18, v25
    v_fmac_f32 v12, v18, v26
    v_fmac_f32 v13, v18, v27
    v_lshlrev_b32 v28, 16, v160
    v_and_b32 v29, s34, v160
    v_lshlrev_b32 v30, 16, v161
    v_and_b32 v31, s34, v161
    v_lshlrev_b32 v32, 16, v162
    v_and_b32 v33, s34, v162
    v_lshlrev_b32 v34, 16, v163
    v_and_b32 v35, s34, v163
    v_fmac_f32 v6, v19, v28
    v_fmac_f32 v7, v19, v29
    v_fmac_f32 v8, v19, v30
    v_fmac_f32 v9, v19, v31
    v_fmac_f32 v10, v19, v32
    v_fmac_f32 v11, v19, v33
    v_fmac_f32 v12, v19, v34
    v_fmac_f32 v13, v19, v35
    s_mov_b64 exec, 1
    ds_add_u32 v165, v166 offset:8260
    s_mov_b64 exec, -1
    s_mov_b32 s54, 4
K1_loop:
    s_cmp_ge_u32 s54, s51
    s_cbranch_scc1 K1_loopend
    s_add_u32 s54, s54, 1
    s_waitcnt vmcnt(12)
    v_dot2_f32_bf16 v16, v36, v2, 0
    v_dot2_f32_bf16 v17, v40, v2, 0
    v_dot2_f32_bf16 v18, v44, v2, 0
    v_dot2_f32_bf16 v19, v48, v2, 0
    v_dot2_f32_bf16 v16, v37, v3, v16
    v_dot2_f32_bf16 v17, v41, v3, v17
    v_dot2_f32_bf16 v18, v45, v3, v18
    v_dot2_f32_bf16 v19, v49, v3, v19
    v_dot2_f32_bf16 v16, v38, v4, v16
    v_dot2_f32_bf16 v17, v42, v4, v17
    v_dot2_f32_bf16 v18, v46, v4, v18
    v_dot2_f32_bf16 v19, v50, v4, v19
    v_dot2_f32_bf16 v16, v39, v5, v16
    v_dot2_f32_bf16 v17, v43, v5, v17
    v_dot2_f32_bf16 v18, v47, v5, v18
    v_dot2_f32_bf16 v19, v51, v5, v19
    s_nop 2
    v_add_f32_dpp v16, v16, v16 quad_perm:[1,0,3,2] row_mask:0xf bank_mask:0xf
    v_add_f32_dpp v17, v17, v17 quad_perm:[1,0,3,2] row_mask:0xf bank_mask:0xf
    v_add_f32_dpp v18, v18, v18 quad_perm:[1,0,3,2] row_mask:0xf bank_mask:0xf
    v_add_f32_dpp v19, v19, v19 quad_perm:[1,0,3,2] row_mask:0xf bank_mask:0xf
    v_add_f32_dpp v16, v16, v16 quad_perm:[2,3,0,1] row_mask:0xf bank_mask:0xf
    v_add_f32_dpp v17, v17, v17 quad_perm:[2,3,0,1] row_mask:0xf bank_mask:0xf
    v_add_f32_dpp v18, v18, v18 quad_perm:[2,3,0,1] row_mask:0xf bank_mask:0xf
    v_add_f32_dpp v19, v19, v19 quad_perm:[2,3,0,1] row_mask:0xf bank_mask:0xf
    v_add_f32_dpp v16, v16, v16 row_half_mirror row_mask:0xf bank_mask:0xf
    v_add_f32_dpp v17, v17, v17 row_half_mirror row_mask:0xf bank_mask:0xf
    v_add_f32_dpp v18, v18, v18 row_half_mirror row_mask:0xf bank_mask:0xf
    v_add_f32_dpp v19, v19, v19 row_half_mirror row_mask:0xf bank_mask:0xf
    v_add_f32_dpp v16, v16, v16 row_mirror row_mask:0xf bank_mask:0xf
    v_add_f32_dpp v17, v17, v17 row_mirror row_mask:0xf bank_mask:0xf
    v_add_f32_dpp v18, v18, v18 row_mirror row_mask:0xf bank_mask:0xf
    v_add_f32_dpp v19, v19, v19 row_mirror row_mask:0xf bank_mask:0xf
    v_max3_f32 v20, v14, v16, v17
    v_max3_f32 v20, v20, v18, v19
    v_sub_f32 v21, v14, v20
    v_mul_f32 v22, s41, v20
    v_mul_f32 v21, s41, v21
    v_fma_f32 v16, v16, s41, -v22
    v_fma_f32 v17, v17, s41, -v22
    v_fma_f32 v18, v18, s41, -v22
    v_fma_f32 v19, v19, s41, -v22
    v_exp_f32 v21, v21
    v_exp_f32 v16, v16
    v_exp_f32 v17, v17
    v_exp_f32 v18, v18
    v_exp_f32 v19, v19
    v_mov_b32 v14, v20
    v_mul_f32 v6, v6, v21
    v_mul_f32 v7, v7, v21
    v_mul_f32 v8, v8, v21
    v_mul_f32 v9, v9, v21
    v_mul_f32 v10, v10, v21
    v_mul_f32 v11, v11, v21
    v_mul_f32 v12, v12, v21
    v_mul_f32 v13, v13, v21
    v_fma_f32 v15, v15, v21, v16
    v_add_f32 v22, v17, v18
    v_add_f32 v15, v15, v19
    v_add_f32 v15, v15, v22
    s_waitcnt vmcnt(8)
    v_lshlrev_b32 v20, 16, v52
    v_and_b32 v21, s34, v52
    v_lshlrev_b32 v22, 16, v53
    v_and_b32 v23, s34, v53
    v_lshlrev_b32 v24, 16, v54
    v_and_b32 v25, s34, v54
    v_lshlrev_b32 v26, 16, v55
    v_and_b32 v27, s34, v55
    v_fmac_f32 v6, v16, v20
    v_fmac_f32 v7, v16, v21
    v_fmac_f32 v8, v16, v22
    v_fmac_f32 v9, v16, v23
    v_fmac_f32 v10, v16, v24
    v_fmac_f32 v11, v16, v25
    v_fmac_f32 v12, v16, v26
    v_fmac_f32 v13, v16, v27
    v_lshlrev_b32 v28, 16, v56
    v_and_b32 v29, s34, v56
    v_lshlrev_b32 v30, 16, v57
    v_and_b32 v31, s34, v57
    v_lshlrev_b32 v32, 16, v58
    v_and_b32 v33, s34, v58
    v_lshlrev_b32 v34, 16, v59
    v_and_b32 v35, s34, v59
    v_fmac_f32 v6, v17, v28
    v_fmac_f32 v7, v17, v29
    v_fmac_f32 v8, v17, v30
    v_fmac_f32 v9, v17, v31
    v_fmac_f32 v10, v17, v32
    v_fmac_f32 v11, v17, v33
    v_fmac_f32 v12, v17, v34
    v_fmac_f32 v13, v17, v35
    v_lshlrev_b32 v20, 16, v60
    v_and_b32 v21, s34, v60
    v_lshlrev_b32 v22, 16, v61
    v_and_b32 v23, s34, v61
    v_lshlrev_b32 v24, 16, v62
    v_and_b32 v25, s34, v62
    v_lshlrev_b32 v26, 16, v63
    v_and_b32 v27, s34, v63
    v_fmac_f32 v6, v18, v20
    v_fmac_f32 v7, v18, v21
    v_fmac_f32 v8, v18, v22
    v_fmac_f32 v9, v18, v23
    v_fmac_f32 v10, v18, v24
    v_fmac_f32 v11, v18, v25
    v_fmac_f32 v12, v18, v26
    v_fmac_f32 v13, v18, v27
    v_lshlrev_b32 v28, 16, v64
    v_and_b32 v29, s34, v64
    v_lshlrev_b32 v30, 16, v65
    v_and_b32 v31, s34, v65
    v_lshlrev_b32 v32, 16, v66
    v_and_b32 v33, s34, v66
    v_lshlrev_b32 v34, 16, v67
    v_and_b32 v35, s34, v67
    v_fmac_f32 v6, v19, v28
    v_fmac_f32 v7, v19, v29
    v_fmac_f32 v8, v19, v30
    v_fmac_f32 v9, v19, v31
    v_fmac_f32 v10, v19, v32
    v_fmac_f32 v11, v19, v33
    v_fmac_f32 v12, v19, v34
    v_fmac_f32 v13, v19, v35
    s_cmp_lt_u32 s53, s51
    s_cselect_b32 s40, s50, 0x40000000
    s_add_u32 s50, s50, 32768
    s_add_u32 s53, s53, 1
    buffer_load_dwordx4 v[36:39], v1, s[8:11], s40 offen offset:0 nt
    buffer_load_dwordx4 v[40:43], v1, s[8:11], s40 offen offset:1024 nt
    buffer_load_dwordx4 v[44:47], v1, s[8:11], s40 offen offset:2048 nt
    buffer_load_dwordx4 v[48:51], v1, s[8:11], s40 offen offset:3072 nt
    buffer_load_dwordx4 v[52:55], v1, s[12:15], s40 offen offset:0 nt
    buffer_load_dwordx4 v[56:59], v1, s[12:15], s40 offen offset:1024 nt
    buffer_load_dwordx4 v[60:63], v1, s[12:15], s40 offen offset:2048 nt
    buffer_load_dwordx4 v[64:67], v1, s[12:15], s40 offen offset:3072 nt
    s_mov_b64 exec, 1
    ds_add_u32 v165, v166 offset:8260
    s_mov_b64 exec, -1
    s_cmp_ge_u32 s54, s51
    s_cbranch_scc1 K1_loopend
    s_add_u32 s54, s54, 1
    s_waitcnt vmcnt(12)
    v_dot2_f32_bf16 v16, v68, v2, 0
    v_dot2_f32_bf16 v17, v72, v2, 0
    v_dot2_f32_bf16 v18, v76, v2, 0
    v_dot2_f32_bf16 v19, v80, v2, 0
    v_dot2_f32_bf16 v16, v69, v3, v16
    v_dot2_f32_bf16 v17, v73, v3, v17
    v_dot2_f32_bf16 v18, v77, v3, v18
    v_dot2_f32_bf16 v19, v81, v3, v19
    v_dot2_f32_bf16 v16, v70, v4, v16
    v_dot2_f32_bf16 v17, v74, v4, v17
    v_dot2_f32_bf16 v18, v78, v4, v18
    v_dot2_f32_bf16 v19, v82, v4, v19
    v_dot2_f32_bf16 v16, v71, v5, v16
    v_dot2_f32_bf16 v17, v75, v5, v17
    v_dot2_f32_bf16 v18, v79, v5, v18
    v_dot2_f32_bf16 v19, v83, v5, v19
    s_nop 2
    v_add_f32_dpp v16, v16, v16 quad_perm:[1,0,3,2] row_mask:0xf bank_mask:0xf
    v_add_f32_dpp v17, v17, v17 quad_perm:[1,0,3,2] row_mask:0xf bank_mask:0xf
    v_add_f32_dpp v18, v18, v18 quad_perm:[1,0,3,2] row_mask:0xf bank_mask:0xf
    v_add_f32_dpp v19, v19, v19 quad_perm:[1,0,3,2] row_mask:0xf bank_mask:0xf
    v_add_f32_dpp v16, v16, v16 quad_perm:[2,3,0,1] row_mask:0xf bank_mask:0xf
    v_add_f32_dpp v17, v17, v17 quad_perm:[2,3,0,1] row_mask:0xf bank_mask:0xf
    v_add_f32_dpp v18, v18, v18 quad_perm:[2,3,0,1] row_mask:0xf bank_mask:0xf
    v_add_f32_dpp v19, v19, v19 quad_perm:[2,3,0,1] row_mask:0xf bank_mask:0xf
    v_add_f32_dpp v16, v16, v16 row_half_mirror row_mask:0xf bank_mask:0xf
    v_add_f32_dpp v17, v17, v17 row_half_mirror row_mask:0xf bank_mask:0xf
    v_add_f32_dpp v18, v18, v18 row_half_mirror row_mask:0xf bank_mask:0xf
    v_add_f32_dpp v19, v19, v19 row_half_mirror row_mask:0xf bank_mask:0xf
    v_add_f32_dpp v16, v16, v16 row_mirror row_mask:0xf bank_mask:0xf
    v_add_f32_dpp v17, v17, v17 row_mirror row_mask:0xf bank_mask:0xf
    v_add_f32_dpp v18, v18, v18 row_mirror row_mask:0xf bank_mask:0xf
    v_add_f32_dpp v19, v19, v19 row_mirror row_mask:0xf bank_mask:0xf
    v_max3_f32 v20, v14, v16, v17
    v_max3_f32 v20, v20, v18, v19
    v_sub_f32 v21, v14, v20
    v_mul_f32 v22, s41, v20
    v_mul_f32 v21, s41, v21
    v_fma_f32 v16, v16, s41, -v22
    v_fma_f32 v17, v17, s41, -v22
    v_fma_f32 v18, v18, s41, -v22
    v_fma_f32 v19, v19, s41, -v22
    v_exp_f32 v21, v21
    v_exp_f32 v16, v16
    v_exp_f32 v17, v17
    v_exp_f32 v18, v18
    v_exp_f32 v19, v19
    v_mov_b32 v14, v20
    v_mul_f32 v6, v6, v21
    v_mul_f32 v7, v7, v21
    v_mul_f32 v8, v8, v21
    v_mul_f32 v9, v9, v21
    v_mul_f32 v10, v10, v21
    v_mul_f32 v11, v11, v21
    v_mul_f32 v12, v12, v21
    v_mul_f32 v13, v13, v21
    v_fma_f32 v15, v15, v21, v16
    v_add_f32 v22, v17, v18
    v_add_f32 v15, v15, v19
    v_add_f32 v15, v15, v22
    s_waitcnt vmcnt(8)
    v_lshlrev_b32 v20, 16, v84
    v_and_b32 v21, s34, v84
    v_lshlrev_b32 v22, 16, v85
    v_and_b32 v23, s34, v85
    v_lshlrev_b32 v24, 16, v86
    v_and_b32 v25, s34, v86
    v_lshlrev_b32 v26, 16, v87
    v_and_b32 v27, s34, v87
    v_fmac_f32 v6, v16, v20
    v_fmac_f32 v7, v16, v21
    v_fmac_f32 v8, v16, v22
    v_fmac_f32 v9, v16, v23
    v_fmac_f32 v10, v16, v24
    v_fmac_f32 v11, v16, v25
    v_fmac_f32 v12, v16, v26
    v_fmac_f32 v13, v16, v27
    v_lshlrev_b32 v28, 16, v88
    v_and_b32 v29, s34, v88
    v_lshlrev_b32 v30, 16, v89
    v_and_b32 v31, s34, v89
    v_lshlrev_b32 v32, 16, v90
    v_and_b32 v33, s34, v90
    v_lshlrev_b32 v34, 16, v91
    v_and_b32 v35, s34, v91
    v_fmac_f32 v6, v17, v28
    v_fmac_f32 v7, v17, v29
    v_fmac_f32 v8, v17, v30
    v_fmac_f32 v9, v17, v31
    v_fmac_f32 v10, v17, v32
    v_fmac_f32 v11, v17, v33
    v_fmac_f32 v12, v17, v34
    v_fmac_f32 v13, v17, v35
    v_lshlrev_b32 v20, 16, v92
    v_and_b32 v21, s34, v92
    v_lshlrev_b32 v22, 16, v93
    v_and_b32 v23, s34, v93
    v_lshlrev_b32 v24, 16, v94
    v_and_b32 v25, s34, v94
    v_lshlrev_b32 v26, 16, v95
    v_and_b32 v27, s34, v95
    v_fmac_f32 v6, v18, v20
    v_fmac_f32 v7, v18, v21
    v_fmac_f32 v8, v18, v22
    v_fmac_f32 v9, v18, v23
    v_fmac_f32 v10, v18, v24
    v_fmac_f32 v11, v18, v25
    v_fmac_f32 v12, v18, v26
    v_fmac_f32 v13, v18, v27
    v_lshlrev_b32 v28, 16, v96
    v_and_b32 v29, s34, v96
    v_lshlrev_b32 v30, 16, v97
    v_and_b32 v31, s34, v97
    v_lshlrev_b32 v32, 16, v98
    v_and_b32 v33, s34, v98
    v_lshlrev_b32 v34, 16, v99
    v_and_b32 v35, s34, v99
    v_fmac_f32 v6, v19, v28
    v_fmac_f32 v7, v19, v29
    v_fmac_f32 v8, v19, v30
    v_fmac_f32 v9, v19, v31
    v_fmac_f32 v10, v19, v32
    v_fmac_f32 v11, v19, v33
    v_fmac_f32 v12, v19, v34
    v_fmac_f32 v13, v19, v35
    s_cmp_lt_u32 s53, s51
    s_cselect_b32 s40, s50, 0x40000000
    s_add_u32 s50, s50, 32768
    s_add_u32 s53, s53, 1
    buffer_load_dwordx4 v[68:71], v1, s[8:11], s40 offen offset:0 nt
    buffer_load_dwordx4 v[72:75], v1, s[8:11], s40 offen offset:1024 nt
    buffer_load_dwordx4 v[76:79], v1, s[8:11], s40 offen offset:2048 nt
    buffer_load_dwordx4 v[80:83], v1, s[8:11], s40 offen offset:3072 nt
    buffer_load_dwordx4 v[84:87], v1, s[12:15], s40 offen offset:0 nt
    buffer_load_dwordx4 v[88:91], v1, s[12:15], s40 offen offset:1024 nt
    buffer_load_dwordx4 v[92:95], v1, s[12:15], s40 offen offset:2048 nt
    buffer_load_dwordx4 v[96:99], v1, s[12:15], s40 offen offset:3072 nt
    s_mov_b64 exec, 1
    ds_add_u32 v165, v166 offset:8260
    s_mov_b64 exec, -1
    s_branch K1_loop
K1_loopend:
    v_mov_b32 v18, v14
    v_mov_b32 v16, v18
    v_mov_b32 v17, v18
    s_nop 1
    v_permlane32_swap_b32 v16, v17
    v_max_f32 v18, v16, v17
    v_mov_b32 v16, v18
    v_mov_b32 v17, v18
    s_nop 1
    v_permlane16_swap_b32 v16, v17
    v_max_f32 v18, v16, v17
    v_sub_f32 v19, v14, v18
    v_mul_f32 v19, s41, v19
    v_exp_f32 v19, v19
    v_mul_f32 v14, s41, v18
    v_mul_f32 v6, v6, v19
    v_mul_f32 v7, v7, v19
    v_mul_f32 v8, v8, v19
    v_mul_f32 v9, v9, v19
    v_mul_f32 v10, v10, v19
    v_mul_f32 v11, v11, v19
    v_mul_f32 v12, v12, v19
    v_mul_f32 v13, v13, v19
    v_mul_f32 v15, v15, v19
    v_mov_b32 v16, v15
    v_mov_b32 v17, v15
    s_nop 1
    v_permlane32_swap_b32 v16, v17
    v_add_f32 v15, v16, v17
    v_mov_b32 v16, v15
    v_mov_b32 v17, v15
    s_nop 1
    v_permlane16_swap_b32 v16, v17
    v_add_f32 v15, v16, v17
    s_nop 1
    v_permlane32_swap_b32 v6, v10
    v_permlane32_swap_b32 v7, v11
    v_permlane32_swap_b32 v8, v12
    v_permlane32_swap_b32 v9, v13
    v_add_f32 v6, v6, v10
    v_add_f32 v7, v7, v11
    v_add_f32 v8, v8, v12
    v_add_f32 v9, v9, v13
    s_nop 1
    v_permlane16_swap_b32 v6, v8
    v_permlane16_swap_b32 v7, v9
    v_add_f32 v6, v6, v8
    v_add_f32 v7, v7, v9
    v_and_b32 v16, 15, v0
    v_lshrrev_b32 v17, 4, v0
    v_lshlrev_b32 v16, 5, v16
    v_lshlrev_b32 v17, 3, v17
    v_add_u32 v16, v16, v17
    s_lshl_b32 s7, s3, 9
    v_add_u32 v16, s7, v16
    ds_write_b64 v16, v[6:7] offset:4096
    s_lshl_b32 s7, s3, 3
    v_mov_b32 v17, s7
    ds_write_b64 v17, v[14:15] offset:8192
    s_waitcnt lgkmcnt(0)
    s_barrier
    s_endpgm
K1_aux:
    s_setprio 3
    s_and_b32 s6, s4, 31
    s_lshr_b32 s7, s4, 5
    v_lshrrev_b32 v10, 4, v0
    v_and_b32 v11, 15, v0
    v_lshlrev_b32 v11, 4, v11
    v_lshrrev_b32 v26, 2, v0
    v_and_b32 v27, 3, v0
    v_lshlrev_b32 v1, 18, v10
    v_add_u32 v1, v1, v11
    s_lshl_b32 s35, s3, 20
    v_add_u32 v1, s35, v1
    v_lshlrev_b32 v12, 6, v10
    s_lshl_b32 s35, s3, 8
    s_lshl_b32 s36, s7, 10
    s_add_u32 s35, s35, s36
    v_add_u32 v12, s35, v12
    s_lshl_b32 s35, s6, 8
    s_sub_u32 s36, 0x400000, s35
    s_waitcnt lgkmcnt(0)
    s_add_u32 s8, s22, s35
    s_addc_u32 s9, s23, 0
    s_and_b32 s9, s9, 0xffff
    s_mov_b32 s10, s36
    s_mov_b32 s11, 0x00020000
    s_mov_b32 s12, s16
    s_and_b32 s13, s17, 0xffff
    s_mov_b32 s14, 2048
    s_mov_b32 s15, 0x00020000
    s_lshl_b32 s41, s7, 2
    s_add_u32 s41, s41, s5
    s_add_u32 s40, s41, 0
    s_and_b32 s40, s40, 7
    s_lshl_b32 s40, s40, 3
    buffer_load_dwordx2 v[16:17], v12, s[12:15], s40 offen
    s_add_u32 s40, s41, 1
    s_and_b32 s40, s40, 7
    s_lshl_b32 s40, s40, 3
    buffer_load_dwordx2 v[18:19], v12, s[12:15], s40 offen
    s_add_u32 s40, s41, 2
    s_and_b32 s40, s40, 7
    s_lshl_b32 s40, s40, 3
    buffer_load_dwordx2 v[20:21], v12, s[12:15], s40 offen
    s_add_u32 s40, s41, 3
    s_and_b32 s40, s40, 7
    s_lshl_b32 s40, s40, 3
    buffer_load_dwordx2 v[22:23], v12, s[12:15], s40 offen
    s_add_u32 s40, s41, 4
    s_and_b32 s40, s40, 7
    s_lshl_b32 s40, s40, 3
    buffer_load_dwordx2 v[24:25], v12, s[12:15], s40 offen
    s_add_u32 s40, s41, 5
    s_and_b32 s40, s40, 7
    s_lshl_b32 s40, s40, 3
    buffer_load_dwordx2 v[26:27], v12, s[12:15], s40 offen
    s_add_u32 s40, s41, 6
    s_and_b32 s40, s40, 7
    s_lshl_b32 s40, s40, 3
    buffer_load_dwordx2 v[28:29], v12, s[12:15], s40 offen
    s_add_u32 s40, s41, 7
    s_and_b32 s40, s40, 7
    s_lshl_b32 s40, s40, 3
    buffer_load_dwordx2 v[30:31], v12, s[12:15], s40 offen
    s_add_u32 s40, s41, 0
    s_and_b32 s40, s40, 7
    s_lshl_b32 s40, s40, 15
    buffer_load_dwordx4 v[32:35], v1, s[8:11], s40 offen
    s_add_u32 s40, s41, 0
    s_and_b32 s40, s40, 7
    s_lshl_b32 s40, s40, 15
    s_add_u32 s40, s40, 8192
    buffer_load_dwordx4 v[36:39], v1, s[8:11], s40 offen
    s_add_u32 s40, s41, 0
    s_and_b32 s40, s40, 7
    s_lshl_b32 s40, s40, 15
    s_add_u32 s40, s40, 16384
    buffer_load_dwordx4 v[40:43], v1, s[8:11], s40 offen
    s_add_u32 s40, s41, 0
    s_and_b32 s40, s40, 7
    s_lshl_b32 s40, s40, 15
    s_add_u32 s40, s40, 24576
    buffer_load_dwordx4 v[44:47], v1, s[8:11], s40 offen
    s_add_u32 s40, s41, 1
    s_and_b32 s40, s40, 7
    s_lshl_b32 s40, s40, 15
    buffer_load_dwordx4 v[48:51], v1, s[8:11], s40 offen
    s_add_u32 s40, s41, 1
    s_and_b32 s40, s40, 7
    s_lshl_b32 s40, s40, 15
    s_add_u32 s40, s40, 8192
    buffer_load_dwordx4 v[52:55], v1, s[8:11], s40 offen
    v_mov_b32 v2, 0
    v_mov_b32 v3, 0
    v_mov_b32 v4, 0
    v_mov_b32 v5, 0
    v_mov_b32 v6, 0
    v_mov_b32 v7, 0
    v_mov_b32 v8, 0
    v_mov_b32 v9, 0
    s_waitcnt vmcnt(5)
    v_lshlrev_b32 v12, 16, v16
    v_lshlrev_b32 v13, 16, v32
    v_and_b32 v14, s34, v32
    v_fmac_f32 v2, v12, v13
    v_fmac_f32 v3, v12, v14
    v_lshlrev_b32 v13, 16, v33
    v_and_b32 v14, s34, v33
    v_fmac_f32 v4, v12, v13
    v_fmac_f32 v5, v12, v14
    v_lshlrev_b32 v13, 16, v34
    v_and_b32 v14, s34, v34
    v_fmac_f32 v6, v12, v13
    v_fmac_f32 v7, v12, v14
    v_lshlrev_b32 v13, 16, v35
    v_and_b32 v14, s34, v35
    v_fmac_f32 v8, v12, v13
    v_fmac_f32 v9, v12, v14
    s_add_u32 s40, s41, 1
    s_and_b32 s40, s40, 7
    s_lshl_b32 s40, s40, 15
    s_add_u32 s40, s40, 16384
    buffer_load_dwordx4 v[56:59], v1, s[8:11], s40 offen
    s_waitcnt vmcnt(5)
    v_and_b32 v12, s34, v16
    v_lshlrev_b32 v13, 16, v36
    v_and_b32 v14, s34, v36
    v_fmac_f32 v2, v12, v13
    v_fmac_f32 v3, v12, v14
    v_lshlrev_b32 v13, 16, v37
    v_and_b32 v14, s34, v37
    v_fmac_f32 v4, v12, v13
    v_fmac_f32 v5, v12, v14
    v_lshlrev_b32 v13, 16, v38
    v_and_b32 v14, s34, v38
    v_fmac_f32 v6, v12, v13
    v_fmac_f32 v7, v12, v14
    v_lshlrev_b32 v13, 16, v39
    v_and_b32 v14, s34, v39
    v_fmac_f32 v8, v12, v13
    v_fmac_f32 v9, v12, v14
    s_add_u32 s40, s41, 1
    s_and_b32 s40, s40, 7
    s_lshl_b32 s40, s40, 15
    s_add_u32 s40, s40, 24576
    buffer_load_dwordx4 v[60:63], v1, s[8:11], s40 offen
    s_waitcnt vmcnt(5)
    v_lshlrev_b32 v12, 16, v17
    v_lshlrev_b32 v13, 16, v40
    v_and_b32 v14, s34, v40
    v_fmac_f32 v2, v12, v13
    v_fmac_f32 v3, v12, v14
    v_lshlrev_b32 v13, 16, v41
    v_and_b32 v14, s34, v41
    v_fmac_f32 v4, v12, v13
    v_fmac_f32 v5, v12, v14
    v_lshlrev_b32 v13, 16, v42
    v_and_b32 v14, s34, v42
    v_fmac_f32 v6, v12, v13
    v_fmac_f32 v7, v12, v14
    v_lshlrev_b32 v13, 16, v43
    v_and_b32 v14, s34, v43
    v_fmac_f32 v8, v12, v13
    v_fmac_f32 v9, v12, v14
    s_add_u32 s40, s41, 2
    s_and_b32 s40, s40, 7
    s_lshl_b32 s40, s40, 15
    buffer_load_dwordx4 v[64:67], v1, s[8:11], s40 offen
    s_waitcnt vmcnt(5)
    v_and_b32 v12, s34, v17
    v_lshlrev_b32 v13, 16, v44
    v_and_b32 v14, s34, v44
    v_fmac_f32 v2, v12, v13
    v_fmac_f32 v3, v12, v14
    v_lshlrev_b32 v13, 16, v45
    v_and_b32 v14, s34, v45
    v_fmac_f32 v4, v12, v13
    v_fmac_f32 v5, v12, v14
    v_lshlrev_b32 v13, 16, v46
    v_and_b32 v14, s34, v46
    v_fmac_f32 v6, v12, v13
    v_fmac_f32 v7, v12, v14
    v_lshlrev_b32 v13, 16, v47
    v_and_b32 v14, s34, v47
    v_fmac_f32 v8, v12, v13
    v_fmac_f32 v9, v12, v14
    s_add_u32 s40, s41, 2
    s_and_b32 s40, s40, 7
    s_lshl_b32 s40, s40, 15
    s_add_u32 s40, s40, 8192
    buffer_load_dwordx4 v[68:71], v1, s[8:11], s40 offen
    s_waitcnt vmcnt(5)
    v_lshlrev_b32 v12, 16, v18
    v_lshlrev_b32 v13, 16, v48
    v_and_b32 v14, s34, v48
    v_fmac_f32 v2, v12, v13
    v_fmac_f32 v3, v12, v14
    v_lshlrev_b32 v13, 16, v49
    v_and_b32 v14, s34, v49
    v_fmac_f32 v4, v12, v13
    v_fmac_f32 v5, v12, v14
    v_lshlrev_b32 v13, 16, v50
    v_and_b32 v14, s34, v50
    v_fmac_f32 v6, v12, v13
    v_fmac_f32 v7, v12, v14
    v_lshlrev_b32 v13, 16, v51
    v_and_b32 v14, s34, v51
    v_fmac_f32 v8, v12, v13
    v_fmac_f32 v9, v12, v14
    s_add_u32 s40, s41, 2
    s_and_b32 s40, s40, 7
    s_lshl_b32 s40, s40, 15
    s_add_u32 s40, s40, 16384
    buffer_load_dwordx4 v[72:75], v1, s[8:11], s40 offen
    s_waitcnt vmcnt(5)
    v_and_b32 v12, s34, v18
    v_lshlrev_b32 v13, 16, v52
    v_and_b32 v14, s34, v52
    v_fmac_f32 v2, v12, v13
    v_fmac_f32 v3, v12, v14
    v_lshlrev_b32 v13, 16, v53
    v_and_b32 v14, s34, v53
    v_fmac_f32 v4, v12, v13
    v_fmac_f32 v5, v12, v14
    v_lshlrev_b32 v13, 16, v54
    v_and_b32 v14, s34, v54
    v_fmac_f32 v6, v12, v13
    v_fmac_f32 v7, v12, v14
    v_lshlrev_b32 v13, 16, v55
    v_and_b32 v14, s34, v55
    v_fmac_f32 v8, v12, v13
    v_fmac_f32 v9, v12, v14
    s_add_u32 s40, s41, 2
    s_and_b32 s40, s40, 7
    s_lshl_b32 s40, s40, 15
    s_add_u32 s40, s40, 24576
    buffer_load_dwordx4 v[76:79], v1, s[8:11], s40 offen
    s_waitcnt vmcnt(5)
    v_lshlrev_b32 v12, 16, v19
    v_lshlrev_b32 v13, 16, v56
    v_and_b32 v14, s34, v56
    v_fmac_f32 v2, v12, v13
    v_fmac_f32 v3, v12, v14
    v_lshlrev_b32 v13, 16, v57
    v_and_b32 v14, s34, v57
    v_fmac_f32 v4, v12, v13
    v_fmac_f32 v5, v12, v14
    v_lshlrev_b32 v13, 16, v58
    v_and_b32 v14, s34, v58
    v_fmac_f32 v6, v12, v13
    v_fmac_f32 v7, v12, v14
    v_lshlrev_b32 v13, 16, v59
    v_and_b32 v14, s34, v59
    v_fmac_f32 v8, v12, v13
    v_fmac_f32 v9, v12, v14
    s_add_u32 s40, s41, 3
    s_and_b32 s40, s40, 7
    s_lshl_b32 s40, s40, 15
    buffer_load_dwordx4 v[80:83], v1, s[8:11], s40 offen
    s_waitcnt vmcnt(5)
    v_and_b32 v12, s34, v19
    v_lshlrev_b32 v13, 16, v60
    v_and_b32 v14, s34, v60
    v_fmac_f32 v2, v12, v13
    v_fmac_f32 v3, v12, v14
    v_lshlrev_b32 v13, 16, v61
    v_and_b32 v14, s34, v61
    v_fmac_f32 v4, v12, v13
    v_fmac_f32 v5, v12, v14
    v_lshlrev_b32 v13, 16, v62
    v_and_b32 v14, s34, v62
    v_fmac_f32 v6, v12, v13
    v_fmac_f32 v7, v12, v14
    v_lshlrev_b32 v13, 16, v63
    v_and_b32 v14, s34, v63
    v_fmac_f32 v8, v12, v13
    v_fmac_f32 v9, v12, v14
    s_add_u32 s40, s41, 3
    s_and_b32 s40, s40, 7
    s_lshl_b32 s40, s40, 15
    s_add_u32 s40, s40, 8192
    buffer_load_dwordx4 v[84:87], v1, s[8:11], s40 offen
    s_waitcnt vmcnt(5)
    v_lshlrev_b32 v12, 16, v20
    v_lshlrev_b32 v13, 16, v64
    v_and_b32 v14, s34, v64
    v_fmac_f32 v2, v12, v13
    v_fmac_f32 v3, v12, v14
    v_lshlrev_b32 v13, 16, v65
    v_and_b32 v14, s34, v65
    v_fmac_f32 v4, v12, v13
    v_fmac_f32 v5, v12, v14
    v_lshlrev_b32 v13, 16, v66
    v_and_b32 v14, s34, v66
    v_fmac_f32 v6, v12, v13
    v_fmac_f32 v7, v12, v14
    v_lshlrev_b32 v13, 16, v67
    v_and_b32 v14, s34, v67
    v_fmac_f32 v8, v12, v13
    v_fmac_f32 v9, v12, v14
    s_add_u32 s40, s41, 3
    s_and_b32 s40, s40, 7
    s_lshl_b32 s40, s40, 15
    s_add_u32 s40, s40, 16384
    buffer_load_dwordx4 v[88:91], v1, s[8:11], s40 offen
    s_waitcnt vmcnt(5)
    v_and_b32 v12, s34, v20
    v_lshlrev_b32 v13, 16, v68
    v_and_b32 v14, s34, v68
    v_fmac_f32 v2, v12, v13
    v_fmac_f32 v3, v12, v14
    v_lshlrev_b32 v13, 16, v69
    v_and_b32 v14, s34, v69
    v_fmac_f32 v4, v12, v13
    v_fmac_f32 v5, v12, v14
    v_lshlrev_b32 v13, 16, v70
    v_and_b32 v14, s34, v70
    v_fmac_f32 v6, v12, v13
    v_fmac_f32 v7, v12, v14
    v_lshlrev_b32 v13, 16, v71
    v_and_b32 v14, s34, v71
    v_fmac_f32 v8, v12, v13
    v_fmac_f32 v9, v12, v14
    s_add_u32 s40, s41, 3
    s_and_b32 s40, s40, 7
    s_lshl_b32 s40, s40, 15
    s_add_u32 s40, s40, 24576
    buffer_load_dwordx4 v[92:95], v1, s[8:11], s40 offen
    s_waitcnt vmcnt(5)
    v_lshlrev_b32 v12, 16, v21
    v_lshlrev_b32 v13, 16, v72
    v_and_b32 v14, s34, v72
    v_fmac_f32 v2, v12, v13
    v_fmac_f32 v3, v12, v14
    v_lshlrev_b32 v13, 16, v73
    v_and_b32 v14, s34, v73
    v_fmac_f32 v4, v12, v13
    v_fmac_f32 v5, v12, v14
    v_lshlrev_b32 v13, 16, v74
    v_and_b32 v14, s34, v74
    v_fmac_f32 v6, v12, v13
    v_fmac_f32 v7, v12, v14
    v_lshlrev_b32 v13, 16, v75
    v_and_b32 v14, s34, v75
    v_fmac_f32 v8, v12, v13
    v_fmac_f32 v9, v12, v14
    s_add_u32 s40, s41, 4
    s_and_b32 s40, s40, 7
    s_lshl_b32 s40, s40, 15
    buffer_load_dwordx4 v[96:99], v1, s[8:11], s40 offen
    s_waitcnt vmcnt(5)
    v_and_b32 v12, s34, v21
    v_lshlrev_b32 v13, 16, v76
    v_and_b32 v14, s34, v76
    v_fmac_f32 v2, v12, v13
    v_fmac_f32 v3, v12, v14
    v_lshlrev_b32 v13, 16, v77
    v_and_b32 v14, s34, v77
    v_fmac_f32 v4, v12, v13
    v_fmac_f32 v5, v12, v14
    v_lshlrev_b32 v13, 16, v78
    v_and_b32 v14, s34, v78
    v_fmac_f32 v6, v12, v13
    v_fmac_f32 v7, v12, v14
    v_lshlrev_b32 v13, 16, v79
    v_and_b32 v14, s34, v79
    v_fmac_f32 v8, v12, v13
    v_fmac_f32 v9, v12, v14
    s_add_u32 s40, s41, 4
    s_and_b32 s40, s40, 7
    s_lshl_b32 s40, s40, 15
    s_add_u32 s40, s40, 8192
    buffer_load_dwordx4 v[100:103], v1, s[8:11], s40 offen
    s_waitcnt vmcnt(5)
    v_lshlrev_b32 v12, 16, v22
    v_lshlrev_b32 v13, 16, v80
    v_and_b32 v14, s34, v80
    v_fmac_f32 v2, v12, v13
    v_fmac_f32 v3, v12, v14
    v_lshlrev_b32 v13, 16, v81
    v_and_b32 v14, s34, v81
    v_fmac_f32 v4, v12, v13
    v_fmac_f32 v5, v12, v14
    v_lshlrev_b32 v13, 16, v82
    v_and_b32 v14, s34, v82
    v_fmac_f32 v6, v12, v13
    v_fmac_f32 v7, v12, v14
    v_lshlrev_b32 v13, 16, v83
    v_and_b32 v14, s34, v83
    v_fmac_f32 v8, v12, v13
    v_fmac_f32 v9, v12, v14
    s_add_u32 s40, s41, 4
    s_and_b32 s40, s40, 7
    s_lshl_b32 s40, s40, 15
    s_add_u32 s40, s40, 16384
    buffer_load_dwordx4 v[104:107], v1, s[8:11], s40 offen
    s_waitcnt vmcnt(5)
    v_and_b32 v12, s34, v22
    v_lshlrev_b32 v13, 16, v84
    v_and_b32 v14, s34, v84
    v_fmac_f32 v2, v12, v13
    v_fmac_f32 v3, v12, v14
    v_lshlrev_b32 v13, 16, v85
    v_and_b32 v14, s34, v85
    v_fmac_f32 v4, v12, v13
    v_fmac_f32 v5, v12, v14
    v_lshlrev_b32 v13, 16, v86
    v_and_b32 v14, s34, v86
    v_fmac_f32 v6, v12, v13
    v_fmac_f32 v7, v12, v14
    v_lshlrev_b32 v13, 16, v87
    v_and_b32 v14, s34, v87
    v_fmac_f32 v8, v12, v13
    v_fmac_f32 v9, v12, v14
    s_add_u32 s40, s41, 4
    s_and_b32 s40, s40, 7
    s_lshl_b32 s40, s40, 15
    s_add_u32 s40, s40, 24576
    buffer_load_dwordx4 v[108:111], v1, s[8:11], s40 offen
    s_waitcnt vmcnt(5)
    v_lshlrev_b32 v12, 16, v23
    v_lshlrev_b32 v13, 16, v88
    v_and_b32 v14, s34, v88
    v_fmac_f32 v2, v12, v13
    v_fmac_f32 v3, v12, v14
    v_lshlrev_b32 v13, 16, v89
    v_and_b32 v14, s34, v89
    v_fmac_f32 v4, v12, v13
    v_fmac_f32 v5, v12, v14
    v_lshlrev_b32 v13, 16, v90
    v_and_b32 v14, s34, v90
    v_fmac_f32 v6, v12, v13
    v_fmac_f32 v7, v12, v14
    v_lshlrev_b32 v13, 16, v91
    v_and_b32 v14, s34, v91
    v_fmac_f32 v8, v12, v13
    v_fmac_f32 v9, v12, v14
    s_add_u32 s40, s41, 5
    s_and_b32 s40, s40, 7
    s_lshl_b32 s40, s40, 15
    buffer_load_dwordx4 v[112:115], v1, s[8:11], s40 offen
    s_waitcnt vmcnt(5)
    v_and_b32 v12, s34, v23
    v_lshlrev_b32 v13, 16, v92
    v_and_b32 v14, s34, v92
    v_fmac_f32 v2, v12, v13
    v_fmac_f32 v3, v12, v14
    v_lshlrev_b32 v13, 16, v93
    v_and_b32 v14, s34, v93
    v_fmac_f32 v4, v12, v13
    v_fmac_f32 v5, v12, v14
    v_lshlrev_b32 v13, 16, v94
    v_and_b32 v14, s34, v94
    v_fmac_f32 v6, v12, v13
    v_fmac_f32 v7, v12, v14
    v_lshlrev_b32 v13, 16, v95
    v_and_b32 v14, s34, v95
    v_fmac_f32 v8, v12, v13
    v_fmac_f32 v9, v12, v14
    s_add_u32 s40, s41, 5
    s_and_b32 s40, s40, 7
    s_lshl_b32 s40, s40, 15
    s_add_u32 s40, s40, 8192
    buffer_load_dwordx4 v[116:119], v1, s[8:11], s40 offen
    s_waitcnt vmcnt(5)
    v_lshlrev_b32 v12, 16, v24
    v_lshlrev_b32 v13, 16, v96
    v_and_b32 v14, s34, v96
    v_fmac_f32 v2, v12, v13
    v_fmac_f32 v3, v12, v14
    v_lshlrev_b32 v13, 16, v97
    v_and_b32 v14, s34, v97
    v_fmac_f32 v4, v12, v13
    v_fmac_f32 v5, v12, v14
    v_lshlrev_b32 v13, 16, v98
    v_and_b32 v14, s34, v98
    v_fmac_f32 v6, v12, v13
    v_fmac_f32 v7, v12, v14
    v_lshlrev_b32 v13, 16, v99
    v_and_b32 v14, s34, v99
    v_fmac_f32 v8, v12, v13
    v_fmac_f32 v9, v12, v14
    s_add_u32 s40, s41, 5
    s_and_b32 s40, s40, 7
    s_lshl_b32 s40, s40, 15
    s_add_u32 s40, s40, 16384
    buffer_load_dwordx4 v[120:123], v1, s[8:11], s40 offen
    s_waitcnt vmcnt(5)
    v_and_b32 v12, s34, v24
    v_lshlrev_b32 v13, 16, v100
    v_and_b32 v14, s34, v100
    v_fmac_f32 v2, v12, v13
    v_fmac_f32 v3, v12, v14
    v_lshlrev_b32 v13, 16, v101
    v_and_b32 v14, s34, v101
    v_fmac_f32 v4, v12, v13
    v_fmac_f32 v5, v12, v14
    v_lshlrev_b32 v13, 16, v102
    v_and_b32 v14, s34, v102
    v_fmac_f32 v6, v12, v13
    v_fmac_f32 v7, v12, v14
    v_lshlrev_b32 v13, 16, v103
    v_and_b32 v14, s34, v103
    v_fmac_f32 v8, v12, v13
    v_fmac_f32 v9, v12, v14
    s_add_u32 s40, s41, 5
    s_and_b32 s40, s40, 7
    s_lshl_b32 s40, s40, 15
    s_add_u32 s40, s40, 24576
    buffer_load_dwordx4 v[124:127], v1, s[8:11], s40 offen
    s_waitcnt vmcnt(5)
    v_lshlrev_b32 v12, 16, v25
    v_lshlrev_b32 v13, 16, v104
    v_and_b32 v14, s34, v104
    v_fmac_f32 v2, v12, v13
    v_fmac_f32 v3, v12, v14
    v_lshlrev_b32 v13, 16, v105
    v_and_b32 v14, s34, v105
    v_fmac_f32 v4, v12, v13
    v_fmac_f32 v5, v12, v14
    v_lshlrev_b32 v13, 16, v106
    v_and_b32 v14, s34, v106
    v_fmac_f32 v6, v12, v13
    v_fmac_f32 v7, v12, v14
    v_lshlrev_b32 v13, 16, v107
    v_and_b32 v14, s34, v107
    v_fmac_f32 v8, v12, v13
    v_fmac_f32 v9, v12, v14
    s_add_u32 s40, s41, 6
    s_and_b32 s40, s40, 7
    s_lshl_b32 s40, s40, 15
    buffer_load_dwordx4 v[128:131], v1, s[8:11], s40 offen
    s_waitcnt vmcnt(5)
    v_and_b32 v12, s34, v25
    v_lshlrev_b32 v13, 16, v108
    v_and_b32 v14, s34, v108
    v_fmac_f32 v2, v12, v13
    v_fmac_f32 v3, v12, v14
    v_lshlrev_b32 v13, 16, v109
    v_and_b32 v14, s34, v109
    v_fmac_f32 v4, v12, v13
    v_fmac_f32 v5, v12, v14
    v_lshlrev_b32 v13, 16, v110
    v_and_b32 v14, s34, v110
    v_fmac_f32 v6, v12, v13
    v_fmac_f32 v7, v12, v14
    v_lshlrev_b32 v13, 16, v111
    v_and_b32 v14, s34, v111
    v_fmac_f32 v8, v12, v13
    v_fmac_f32 v9, v12, v14
    s_add_u32 s40, s41, 6
    s_and_b32 s40, s40, 7
    s_lshl_b32 s40, s40, 15
    s_add_u32 s40, s40, 8192
    buffer_load_dwordx4 v[132:135], v1, s[8:11], s40 offen
    s_waitcnt vmcnt(5)
    v_lshlrev_b32 v12, 16, v26
    v_lshlrev_b32 v13, 16, v112
    v_and_b32 v14, s34, v112
    v_fmac_f32 v2, v12, v13
    v_fmac_f32 v3, v12, v14
    v_lshlrev_b32 v13, 16, v113
    v_and_b32 v14, s34, v113
    v_fmac_f32 v4, v12, v13
    v_fmac_f32 v5, v12, v14
    v_lshlrev_b32 v13, 16, v114
    v_and_b32 v14, s34, v114
    v_fmac_f32 v6, v12, v13
    v_fmac_f32 v7, v12, v14
    v_lshlrev_b32 v13, 16, v115
    v_and_b32 v14, s34, v115
    v_fmac_f32 v8, v12, v13
    v_fmac_f32 v9, v12, v14
    s_add_u32 s40, s41, 6
    s_and_b32 s40, s40, 7
    s_lshl_b32 s40, s40, 15
    s_add_u32 s40, s40, 16384
    buffer_load_dwordx4 v[136:139], v1, s[8:11], s40 offen
    s_waitcnt vmcnt(5)
    v_and_b32 v12, s34, v26
    v_lshlrev_b32 v13, 16, v116
    v_and_b32 v14, s34, v116
    v_fmac_f32 v2, v12, v13
    v_fmac_f32 v3, v12, v14
    v_lshlrev_b32 v13, 16, v117
    v_and_b32 v14, s34, v117
    v_fmac_f32 v4, v12, v13
    v_fmac_f32 v5, v12, v14
    v_lshlrev_b32 v13, 16, v118
    v_and_b32 v14, s34, v118
    v_fmac_f32 v6, v12, v13
    v_fmac_f32 v7, v12, v14
    v_lshlrev_b32 v13, 16, v119
    v_and_b32 v14, s34, v119
    v_fmac_f32 v8, v12, v13
    v_fmac_f32 v9, v12, v14
    s_add_u32 s40, s41, 6
    s_and_b32 s40, s40, 7
    s_lshl_b32 s40, s40, 15
    s_add_u32 s40, s40, 24576
    buffer_load_dwordx4 v[140:143], v1, s[8:11], s40 offen
    s_waitcnt vmcnt(5)
    v_lshlrev_b32 v12, 16, v27
    v_lshlrev_b32 v13, 16, v120
    v_and_b32 v14, s34, v120
    v_fmac_f32 v2, v12, v13
    v_fmac_f32 v3, v12, v14
    v_lshlrev_b32 v13, 16, v121
    v_and_b32 v14, s34, v121
    v_fmac_f32 v4, v12, v13
    v_fmac_f32 v5, v12, v14
    v_lshlrev_b32 v13, 16, v122
    v_and_b32 v14, s34, v122
    v_fmac_f32 v6, v12, v13
    v_fmac_f32 v7, v12, v14
    v_lshlrev_b32 v13, 16, v123
    v_and_b32 v14, s34, v123
    v_fmac_f32 v8, v12, v13
    v_fmac_f32 v9, v12, v14
    s_add_u32 s40, s41, 7
    s_and_b32 s40, s40, 7
    s_lshl_b32 s40, s40, 15
    buffer_load_dwordx4 v[144:147], v1, s[8:11], s40 offen
    s_waitcnt vmcnt(5)
    v_and_b32 v12, s34, v27
    v_lshlrev_b32 v13, 16, v124
    v_and_b32 v14, s34, v124
    v_fmac_f32 v2, v12, v13
    v_fmac_f32 v3, v12, v14
    v_lshlrev_b32 v13, 16, v125
    v_and_b32 v14, s34, v125
    v_fmac_f32 v4, v12, v13
    v_fmac_f32 v5, v12, v14
    v_lshlrev_b32 v13, 16, v126
    v_and_b32 v14, s34, v126
    v_fmac_f32 v6, v12, v13
    v_fmac_f32 v7, v12, v14
    v_lshlrev_b32 v13, 16, v127
    v_and_b32 v14, s34, v127
    v_fmac_f32 v8, v12, v13
    v_fmac_f32 v9, v12, v14
    s_add_u32 s40, s41, 7
    s_and_b32 s40, s40, 7
    s_lshl_b32 s40, s40, 15
    s_add_u32 s40, s40, 8192
    buffer_load_dwordx4 v[148:151], v1, s[8:11], s40 offen
    s_waitcnt vmcnt(5)
    v_lshlrev_b32 v12, 16, v28
    v_lshlrev_b32 v13, 16, v128
    v_and_b32 v14, s34, v128
    v_fmac_f32 v2, v12, v13
    v_fmac_f32 v3, v12, v14
    v_lshlrev_b32 v13, 16, v129
    v_and_b32 v14, s34, v129
    v_fmac_f32 v4, v12, v13
    v_fmac_f32 v5, v12, v14
    v_lshlrev_b32 v13, 16, v130
    v_and_b32 v14, s34, v130
    v_fmac_f32 v6, v12, v13
    v_fmac_f32 v7, v12, v14
    v_lshlrev_b32 v13, 16, v131
    v_and_b32 v14, s34, v131
    v_fmac_f32 v8, v12, v13
    v_fmac_f32 v9, v12, v14
    s_add_u32 s40, s41, 7
    s_and_b32 s40, s40, 7
    s_lshl_b32 s40, s40, 15
    s_add_u32 s40, s40, 16384
    buffer_load_dwordx4 v[152:155], v1, s[8:11], s40 offen
    s_waitcnt vmcnt(5)
    v_and_b32 v12, s34, v28
    v_lshlrev_b32 v13, 16, v132
    v_and_b32 v14, s34, v132
    v_fmac_f32 v2, v12, v13
    v_fmac_f32 v3, v12, v14
    v_lshlrev_b32 v13, 16, v133
    v_and_b32 v14, s34, v133
    v_fmac_f32 v4, v12, v13
    v_fmac_f32 v5, v12, v14
    v_lshlrev_b32 v13, 16, v134
    v_and_b32 v14, s34, v134
    v_fmac_f32 v6, v12, v13
    v_fmac_f32 v7, v12, v14
    v_lshlrev_b32 v13, 16, v135
    v_and_b32 v14, s34, v135
    v_fmac_f32 v8, v12, v13
    v_fmac_f32 v9, v12, v14
    s_add_u32 s40, s41, 7
    s_and_b32 s40, s40, 7
    s_lshl_b32 s40, s40, 15
    s_add_u32 s40, s40, 24576
    buffer_load_dwordx4 v[156:159], v1, s[8:11], s40 offen
    s_waitcnt vmcnt(5)
    v_lshlrev_b32 v12, 16, v29
    v_lshlrev_b32 v13, 16, v136
    v_and_b32 v14, s34, v136
    v_fmac_f32 v2, v12, v13
    v_fmac_f32 v3, v12, v14
    v_lshlrev_b32 v13, 16, v137
    v_and_b32 v14, s34, v137
    v_fmac_f32 v4, v12, v13
    v_fmac_f32 v5, v12, v14
    v_lshlrev_b32 v13, 16, v138
    v_and_b32 v14, s34, v138
    v_fmac_f32 v6, v12, v13
    v_fmac_f32 v7, v12, v14
    v_lshlrev_b32 v13, 16, v139
    v_and_b32 v14, s34, v139
    v_fmac_f32 v8, v12, v13
    v_fmac_f32 v9, v12, v14
    s_waitcnt vmcnt(4)
    v_and_b32 v12, s34, v29
    v_lshlrev_b32 v13, 16, v140
    v_and_b32 v14, s34, v140
    v_fmac_f32 v2, v12, v13
    v_fmac_f32 v3, v12, v14
    v_lshlrev_b32 v13, 16, v141
    v_and_b32 v14, s34, v141
    v_fmac_f32 v4, v12, v13
    v_fmac_f32 v5, v12, v14
    v_lshlrev_b32 v13, 16, v142
    v_and_b32 v14, s34, v142
    v_fmac_f32 v6, v12, v13
    v_fmac_f32 v7, v12, v14
    v_lshlrev_b32 v13, 16, v143
    v_and_b32 v14, s34, v143
    v_fmac_f32 v8, v12, v13
    v_fmac_f32 v9, v12, v14
    s_waitcnt vmcnt(3)
    v_lshlrev_b32 v12, 16, v30
    v_lshlrev_b32 v13, 16, v144
    v_and_b32 v14, s34, v144
    v_fmac_f32 v2, v12, v13
    v_fmac_f32 v3, v12, v14
    v_lshlrev_b32 v13, 16, v145
    v_and_b32 v14, s34, v145
    v_fmac_f32 v4, v12, v13
    v_fmac_f32 v5, v12, v14
    v_lshlrev_b32 v13, 16, v146
    v_and_b32 v14, s34, v146
    v_fmac_f32 v6, v12, v13
    v_fmac_f32 v7, v12, v14
    v_lshlrev_b32 v13, 16, v147
    v_and_b32 v14, s34, v147
    v_fmac_f32 v8, v12, v13
    v_fmac_f32 v9, v12, v14
    s_waitcnt vmcnt(2)
    v_and_b32 v12, s34, v30
    v_lshlrev_b32 v13, 16, v148
    v_and_b32 v14, s34, v148
    v_fmac_f32 v2, v12, v13
    v_fmac_f32 v3, v12, v14
    v_lshlrev_b32 v13, 16, v149
    v_and_b32 v14, s34, v149
    v_fmac_f32 v4, v12, v13
    v_fmac_f32 v5, v12, v14
    v_lshlrev_b32 v13, 16, v150
    v_and_b32 v14, s34, v150
    v_fmac_f32 v6, v12, v13
    v_fmac_f32 v7, v12, v14
    v_lshlrev_b32 v13, 16, v151
    v_and_b32 v14, s34, v151
    v_fmac_f32 v8, v12, v13
    v_fmac_f32 v9, v12, v14
    s_waitcnt vmcnt(1)
    v_lshlrev_b32 v12, 16, v31
    v_lshlrev_b32 v13, 16, v152
    v_and_b32 v14, s34, v152
    v_fmac_f32 v2, v12, v13
    v_fmac_f32 v3, v12, v14
    v_lshlrev_b32 v13, 16, v153
    v_and_b32 v14, s34, v153
    v_fmac_f32 v4, v12, v13
    v_fmac_f32 v5, v12, v14
    v_lshlrev_b32 v13, 16, v154
    v_and_b32 v14, s34, v154
    v_fmac_f32 v6, v12, v13
    v_fmac_f32 v7, v12, v14
    v_lshlrev_b32 v13, 16, v155
    v_and_b32 v14, s34, v155
    v_fmac_f32 v8, v12, v13
    v_fmac_f32 v9, v12, v14
    s_waitcnt vmcnt(0)
    v_and_b32 v12, s34, v31
    v_lshlrev_b32 v13, 16, v156
    v_and_b32 v14, s34, v156
    v_fmac_f32 v2, v12, v13
    v_fmac_f32 v3, v12, v14
    v_lshlrev_b32 v13, 16, v157
    v_and_b32 v14, s34, v157
    v_fmac_f32 v4, v12, v13
    v_fmac_f32 v5, v12, v14
    v_lshlrev_b32 v13, 16, v158
    v_and_b32 v14, s34, v158
    v_fmac_f32 v6, v12, v13
    v_fmac_f32 v7, v12, v14
    v_lshlrev_b32 v13, 16, v159
    v_and_b32 v14, s34, v159
    v_fmac_f32 v8, v12, v13
    v_fmac_f32 v9, v12, v14
    s_nop 1
    v_permlane32_swap_b32 v2, v6
    v_permlane32_swap_b32 v3, v7
    v_permlane32_swap_b32 v4, v8
    v_permlane32_swap_b32 v5, v9
    v_add_f32 v2, v2, v6
    v_add_f32 v3, v3, v7
    v_add_f32 v4, v4, v8
    v_add_f32 v5, v5, v9
    s_nop 1
    v_permlane16_swap_b32 v2, v4
    v_permlane16_swap_b32 v3, v5
    v_add_f32 v2, v2, v4
    v_add_f32 v3, v3, v5
    v_lshlrev_b32 v12, 1, v11
    v_lshlrev_b32 v13, 3, v10
    v_add_u32 v12, v12, v13
    s_lshl_b32 s35, s3, 9
    v_add_u32 v15, s35, v12
    ds_write_b64 v15, v[2:3] offset:0
    v_mov_b32 v12, 0
    v_mov_b32 v13, 0
    ds_write_b64 v12, v[12:13] offset:8256
    ds_write_b32 v12, v12 offset:8264
    v_lshrrev_b32 v26, 2, v0
    v_and_b32 v27, 3, v0
    s_waitcnt lgkmcnt(0)
K1_qdone:
    s_barrier
    v_lshlrev_b32 v12, 1, v11
    v_lshlrev_b32 v13, 3, v10
    v_add_u32 v12, v12, v13
    s_lshl_b32 s35, s3, 9
    v_add_u32 v15, s35, v12
    s_setprio 3
    s_lshl_b32 s35, s6, 17
    s_add_u32 s8, s24, s35
    s_addc_u32 s9, s25, 0
    s_and_b32 s9, s9, 0xffff
    s_mov_b32 s10, 131072
    s_mov_b32 s11, 0x00020000
    v_lshlrev_b32 v1, 10, v10
    v_add_u32 v1, v1, v11
    s_lshl_b32 s35, s3, 8
    v_add_u32 v1, s35, v1
    s_lshl_b32 s58, s3, 15
    s_add_u32 s58, s58, 12544
    s_add_u32 s36, s41, 0
    s_and_b32 s36, s36, 7
    s_lshl_b32 s40, s36, 14
    s_lshl_b32 s36, s36, 12
    s_add_u32 s36, s36, s58
    s_mov_b32 m0, s36
    s_nop 0
    buffer_load_dwordx4 v1, s[8:11], s40 offen  lds
    s_add_u32 s40, s40, 4096
    s_add_u32 s36, s36, 1024
    s_mov_b32 m0, s36
    s_nop 0
    buffer_load_dwordx4 v1, s[8:11], s40 offen  lds
    s_add_u32 s40, s40, 4096
    s_add_u32 s36, s36, 1024
    s_mov_b32 m0, s36
    s_nop 0
    buffer_load_dwordx4 v1, s[8:11], s40 offen  lds
    s_add_u32 s40, s40, 4096
    s_add_u32 s36, s36, 1024
    s_mov_b32 m0, s36
    s_nop 0
    buffer_load_dwordx4 v1, s[8:11], s40 offen  lds
    s_waitcnt vmcnt(0)
    s_add_u32 s36, s41, 1
    s_and_b32 s36, s36, 7
    s_lshl_b32 s40, s36, 14
    s_lshl_b32 s36, s36, 12
    s_add_u32 s36, s36, s58
    s_mov_b32 m0, s36
    s_nop 0
    buffer_load_dwordx4 v1, s[8:11], s40 offen  lds
    s_add_u32 s40, s40, 4096
    s_add_u32 s36, s36, 1024
    s_mov_b32 m0, s36
    s_nop 0
    buffer_load_dwordx4 v1, s[8:11], s40 offen  lds
    s_add_u32 s40, s40, 4096
    s_add_u32 s36, s36, 1024
    s_mov_b32 m0, s36
    s_nop 0
    buffer_load_dwordx4 v1, s[8:11], s40 offen  lds
    s_add_u32 s40, s40, 4096
    s_add_u32 s36, s36, 1024
    s_mov_b32 m0, s36
    s_nop 0
    buffer_load_dwordx4 v1, s[8:11], s40 offen  lds
    s_waitcnt vmcnt(0)
    s_add_u32 s36, s41, 2
    s_and_b32 s36, s36, 7
    s_lshl_b32 s40, s36, 14
    s_lshl_b32 s36, s36, 12
    s_add_u32 s36, s36, s58
    s_mov_b32 m0, s36
    s_nop 0
    buffer_load_dwordx4 v1, s[8:11], s40 offen  lds
    s_add_u32 s40, s40, 4096
    s_add_u32 s36, s36, 1024
    s_mov_b32 m0, s36
    s_nop 0
    buffer_load_dwordx4 v1, s[8:11], s40 offen  lds
    s_add_u32 s40, s40, 4096
    s_add_u32 s36, s36, 1024
    s_mov_b32 m0, s36
    s_nop 0
    buffer_load_dwordx4 v1, s[8:11], s40 offen  lds
    s_add_u32 s40, s40, 4096
    s_add_u32 s36, s36, 1024
    s_mov_b32 m0, s36
    s_nop 0
    buffer_load_dwordx4 v1, s[8:11], s40 offen  lds
    s_waitcnt vmcnt(0)
    s_add_u32 s36, s41, 3
    s_and_b32 s36, s36, 7
    s_lshl_b32 s40, s36, 14
    s_lshl_b32 s36, s36, 12
    s_add_u32 s36, s36, s58
    s_mov_b32 m0, s36
    s_nop 0
    buffer_load_dwordx4 v1, s[8:11], s40 offen  lds
    s_add_u32 s40, s40, 4096
    s_add_u32 s36, s36, 1024
    s_mov_b32 m0, s36
    s_nop 0
    buffer_load_dwordx4 v1, s[8:11], s40 offen  lds
    s_add_u32 s40, s40, 4096
    s_add_u32 s36, s36, 1024
    s_mov_b32 m0, s36
    s_nop 0
    buffer_load_dwordx4 v1, s[8:11], s40 offen  lds
    s_add_u32 s40, s40, 4096
    s_add_u32 s36, s36, 1024
    s_mov_b32 m0, s36
    s_nop 0
    buffer_load_dwordx4 v1, s[8:11], s40 offen  lds
    s_waitcnt vmcnt(0)
    s_add_u32 s36, s41, 4
    s_and_b32 s36, s36, 7
    s_lshl_b32 s40, s36, 14
    s_lshl_b32 s36, s36, 12
    s_add_u32 s36, s36, s58
    s_mov_b32 m0, s36
    s_nop 0
    buffer_load_dwordx4 v1, s[8:11], s40 offen  lds
    s_add_u32 s40, s40, 4096
    s_add_u32 s36, s36, 1024
    s_mov_b32 m0, s36
    s_nop 0
    buffer_load_dwordx4 v1, s[8:11], s40 offen  lds
    s_add_u32 s40, s40, 4096
    s_add_u32 s36, s36, 1024
    s_mov_b32 m0, s36
    s_nop 0
    buffer_load_dwordx4 v1, s[8:11], s40 offen  lds
    s_add_u32 s40, s40, 4096
    s_add_u32 s36, s36, 1024
    s_mov_b32 m0, s36
    s_nop 0
    buffer_load_dwordx4 v1, s[8:11], s40 offen  lds
    s_waitcnt vmcnt(0)
    s_add_u32 s36, s41, 5
    s_and_b32 s36, s36, 7
    s_lshl_b32 s40, s36, 14
    s_lshl_b32 s36, s36, 12
    s_add_u32 s36, s36, s58
    s_mov_b32 m0, s36
    s_nop 0
    buffer_load_dwordx4 v1, s[8:11], s40 offen  lds
    s_add_u32 s40, s40, 4096
    s_add_u32 s36, s36, 1024
    s_mov_b32 m0, s36
    s_nop 0
    buffer_load_dwordx4 v1, s[8:11], s40 offen  lds
    s_add_u32 s40, s40, 4096
    s_add_u32 s36, s36, 1024
    s_mov_b32 m0, s36
    s_nop 0
    buffer_load_dwordx4 v1, s[8:11], s40 offen  lds
    s_add_u32 s40, s40, 4096
    s_add_u32 s36, s36, 1024
    s_mov_b32 m0, s36
    s_nop 0
    buffer_load_dwordx4 v1, s[8:11], s40 offen  lds
    s_waitcnt vmcnt(0)
    s_add_u32 s36, s41, 6
    s_and_b32 s36, s36, 7
    s_lshl_b32 s40, s36, 14
    s_lshl_b32 s36, s36, 12
    s_add_u32 s36, s36, s58
    s_mov_b32 m0, s36
    s_nop 0
    buffer_load_dwordx4 v1, s[8:11], s40 offen  lds
    s_add_u32 s40, s40, 4096
    s_add_u32 s36, s36, 1024
    s_mov_b32 m0, s36
    s_nop 0
    buffer_load_dwordx4 v1, s[8:11], s40 offen  lds
    s_add_u32 s40, s40, 4096
    s_add_u32 s36, s36, 1024
    s_mov_b32 m0, s36
    s_nop 0
    buffer_load_dwordx4 v1, s[8:11], s40 offen  lds
    s_add_u32 s40, s40, 4096
    s_add_u32 s36, s36, 1024
    s_mov_b32 m0, s36
    s_nop 0
    buffer_load_dwordx4 v1, s[8:11], s40 offen  lds
    s_waitcnt vmcnt(0)
    s_add_u32 s36, s41, 7
    s_and_b32 s36, s36, 7
    s_lshl_b32 s40, s36, 14
    s_lshl_b32 s36, s36, 12
    s_add_u32 s36, s36, s58
    s_mov_b32 m0, s36
    s_nop 0
    buffer_load_dwordx4 v1, s[8:11], s40 offen  lds
    s_add_u32 s40, s40, 4096
    s_add_u32 s36, s36, 1024
    s_mov_b32 m0, s36
    s_nop 0
    buffer_load_dwordx4 v1, s[8:11], s40 offen  lds
    s_add_u32 s40, s40, 4096
    s_add_u32 s36, s36, 1024
    s_mov_b32 m0, s36
    s_nop 0
    buffer_load_dwordx4 v1, s[8:11], s40 offen  lds
    s_add_u32 s40, s40, 4096
    s_add_u32 s36, s36, 1024
    s_mov_b32 m0, s36
    s_nop 0
    buffer_load_dwordx4 v1, s[8:11], s40 offen  lds
    s_waitcnt vmcnt(0)
    v_mov_b32 v30, 0
    s_cmp_lg_u32 s3, 0
    s_cbranch_scc1 K1_twait
K1_pwait:
    ds_read_b32 v31, v30 offset:8260
    s_waitcnt lgkmcnt(0)
    v_readfirstlane_b32 s35, v31
    s_cmp_ge_u32 s35, 88
    s_cbranch_scc1 K1_pdone
    s_sleep 8
    s_branch K1_pwait
K1_pdone:
    s_mov_b32 s52, s44
    s_and_b32 s53, s45, 0xffff
    s_mov_b32 s54, 256
    s_mov_b32 s55, 0x00020000
    v_mov_b32 v31, 1
    s_mov_b64 exec, 1
    buffer_atomic_add v31, v30, s[52:55], 0 offen sc0
    s_waitcnt vmcnt(0)
    v_add_u32 v31, 1, v31
    ds_write_b32 v30, v31 offset:8264
    s_mov_b64 exec, -1
K1_twait:
    ds_read_b32 v31, v30 offset:8264
    s_waitcnt lgkmcnt(0)
    v_readfirstlane_b32 s59, v31
    s_cmp_lg_u32 s59, 0
    s_cbranch_scc1 K1_tdone
    s_sleep 8
    s_branch K1_twait
K1_tdone:
    s_sub_u32 s59, s59, 1
    s_cmp_ge_u32 s59, 56
    s_cbranch_scc1 K1_noffn
    s_lshl_b32 s35, s59, 6
    s_sub_u32 s36, 1835008, s35
    s_add_u32 s8, s28, s35
    s_addc_u32 s9, s29, 0
    s_and_b32 s9, s9, 0xffff
    s_mov_b32 s10, s36
    s_mov_b32 s11, 0x00020000
    s_lshl_b32 s35, s59, 15
    s_add_u32 s36, s30, s35
    s_addc_u32 s37, s31, 0
    s_and_b32 s37, s37, 0xffff
    s_mov_b32 s38, 32768
    s_mov_b32 s39, 0x00020000
    v_lshlrev_b32 v28, 3, v26
    s_lshl_b32 s35, s3, 7
    v_add_u32 v28, s35, v28
    s_movk_i32 s35, 3584
    v_mul_lo_u32 v29, v28, s35
    v_lshlrev_b32 v30, 4, v27
    v_add_u32 v29, v29, v30
    v_lshlrev_b32 v28, 1, v28
    buffer_load_dwordx4 v[18:21], v28, s[12:15], 0 offen
    buffer_load_dwordx4 v[22:25], v28, s[12:15], 0 offen offset:1024
    buffer_load_dwordx4 v[32:35], v29, s[8:11], 0 offen
    s_mov_b32 s40, 3584
    buffer_load_dwordx4 v[36:39], v29, s[8:11], s40 offen
    s_mov_b32 s40, 7168
    buffer_load_dwordx4 v[40:43], v29, s[8:11], s40 offen
    s_mov_b32 s40, 10752
    buffer_load_dwordx4 v[44:47], v29, s[8:11], s40 offen
    s_mov_b32 s40, 14336
    buffer_load_dwordx4 v[48:51], v29, s[8:11], s40 offen
    s_mov_b32 s40, 17920
    buffer_load_dwordx4 v[52:55], v29, s[8:11], s40 offen
    s_mov_b32 s40, 21504
    buffer_load_dwordx4 v[56:59], v29, s[8:11], s40 offen
    s_mov_b32 s40, 25088
    buffer_load_dwordx4 v[60:63], v29, s[8:11], s40 offen
    v_lshlrev_b32 v29, 13, v10
    v_add_u32 v29, v29, v11
    s_lshl_b32 s35, s3, 8
    v_add_u32 v29, s35, v29
    s_movk_i32 s40, 4096
    buffer_load_dwordx4 v[64:67], v29, s[36:39], 0 offen offset:0 nt
    buffer_load_dwordx4 v[68:71], v29, s[36:39], 0 offen offset:1024 nt
    buffer_load_dwordx4 v[72:75], v29, s[36:39], 0 offen offset:2048 nt
    buffer_load_dwordx4 v[76:79], v29, s[36:39], 0 offen offset:3072 nt
    buffer_load_dwordx4 v[80:83], v29, s[36:39], s40 offen offset:0 nt
    buffer_load_dwordx4 v[84:87], v29, s[36:39], s40 offen offset:1024 nt
    buffer_load_dwordx4 v[88:91], v29, s[36:39], s40 offen offset:2048 nt
    buffer_load_dwordx4 v[92:95], v29, s[36:39], s40 offen offset:3072 nt
    v_mov_b32 v96, 0
    v_mov_b32 v97, 0
    v_mov_b32 v98, 0
    v_mov_b32 v99, 0
    v_mov_b32 v100, 0
    v_mov_b32 v101, 0
    v_mov_b32 v102, 0
    v_mov_b32 v103, 0
    v_mov_b32 v104, 0
    v_mov_b32 v105, 0
    v_mov_b32 v106, 0
    v_mov_b32 v107, 0
    v_mov_b32 v108, 0
    v_mov_b32 v109, 0
    v_mov_b32 v110, 0
    v_mov_b32 v111, 0
    s_waitcnt vmcnt(15)
    v_lshlrev_b32 v28, 16, v18
    v_lshlrev_b32 v29, 16, v22
    v_lshlrev_b32 v30, 16, v32
    v_and_b32 v31, s34, v32
    v_fmac_f32 v96, v28, v30
    v_fmac_f32 v97, v28, v31
    v_fmac_f32 v104, v29, v30
    v_fmac_f32 v105, v29, v31
    v_lshlrev_b32 v30, 16, v33
    v_and_b32 v31, s34, v33
    v_fmac_f32 v98, v28, v30
    v_fmac_f32 v99, v28, v31
    v_fmac_f32 v106, v29, v30
    v_fmac_f32 v107, v29, v31
    v_lshlrev_b32 v30, 16, v34
    v_and_b32 v31, s34, v34
    v_fmac_f32 v100, v28, v30
    v_fmac_f32 v101, v28, v31
    v_fmac_f32 v108, v29, v30
    v_fmac_f32 v109, v29, v31
    v_lshlrev_b32 v30, 16, v35
    v_and_b32 v31, s34, v35
    v_fmac_f32 v102, v28, v30
    v_fmac_f32 v103, v28, v31
    v_fmac_f32 v110, v29, v30
    v_fmac_f32 v111, v29, v31
    s_waitcnt vmcnt(14)
    v_and_b32 v28, s34, v18
    v_and_b32 v29, s34, v22
    v_lshlrev_b32 v30, 16, v36
    v_and_b32 v31, s34, v36
    v_fmac_f32 v96, v28, v30
    v_fmac_f32 v97, v28, v31
    v_fmac_f32 v104, v29, v30
    v_fmac_f32 v105, v29, v31
    v_lshlrev_b32 v30, 16, v37
    v_and_b32 v31, s34, v37
    v_fmac_f32 v98, v28, v30
    v_fmac_f32 v99, v28, v31
    v_fmac_f32 v106, v29, v30
    v_fmac_f32 v107, v29, v31
    v_lshlrev_b32 v30, 16, v38
    v_and_b32 v31, s34, v38
    v_fmac_f32 v100, v28, v30
    v_fmac_f32 v101, v28, v31
    v_fmac_f32 v108, v29, v30
    v_fmac_f32 v109, v29, v31
    v_lshlrev_b32 v30, 16, v39
    v_and_b32 v31, s34, v39
    v_fmac_f32 v102, v28, v30
    v_fmac_f32 v103, v28, v31
    v_fmac_f32 v110, v29, v30
    v_fmac_f32 v111, v29, v31
    s_waitcnt vmcnt(13)
    v_lshlrev_b32 v28, 16, v19
    v_lshlrev_b32 v29, 16, v23
    v_lshlrev_b32 v30, 16, v40
    v_and_b32 v31, s34, v40
    v_fmac_f32 v96, v28, v30
    v_fmac_f32 v97, v28, v31
    v_fmac_f32 v104, v29, v30
    v_fmac_f32 v105, v29, v31
    v_lshlrev_b32 v30, 16, v41
    v_and_b32 v31, s34, v41
    v_fmac_f32 v98, v28, v30
    v_fmac_f32 v99, v28, v31
    v_fmac_f32 v106, v29, v30
    v_fmac_f32 v107, v29, v31
    v_lshlrev_b32 v30, 16, v42
    v_and_b32 v31, s34, v42
    v_fmac_f32 v100, v28, v30
    v_fmac_f32 v101, v28, v31
    v_fmac_f32 v108, v29, v30
    v_fmac_f32 v109, v29, v31
    v_lshlrev_b32 v30, 16, v43
    v_and_b32 v31, s34, v43
    v_fmac_f32 v102, v28, v30
    v_fmac_f32 v103, v28, v31
    v_fmac_f32 v110, v29, v30
    v_fmac_f32 v111, v29, v31
    s_waitcnt vmcnt(12)
    v_and_b32 v28, s34, v19
    v_and_b32 v29, s34, v23
    v_lshlrev_b32 v30, 16, v44
    v_and_b32 v31, s34, v44
    v_fmac_f32 v96, v28, v30
    v_fmac_f32 v97, v28, v31
    v_fmac_f32 v104, v29, v30
    v_fmac_f32 v105, v29, v31
    v_lshlrev_b32 v30, 16, v45
    v_and_b32 v31, s34, v45
    v_fmac_f32 v98, v28, v30
    v_fmac_f32 v99, v28, v31
    v_fmac_f32 v106, v29, v30
    v_fmac_f32 v107, v29, v31
    v_lshlrev_b32 v30, 16, v46
    v_and_b32 v31, s34, v46
    v_fmac_f32 v100, v28, v30
    v_fmac_f32 v101, v28, v31
    v_fmac_f32 v108, v29, v30
    v_fmac_f32 v109, v29, v31
    v_lshlrev_b32 v30, 16, v47
    v_and_b32 v31, s34, v47
    v_fmac_f32 v102, v28, v30
    v_fmac_f32 v103, v28, v31
    v_fmac_f32 v110, v29, v30
    v_fmac_f32 v111, v29, v31
    s_waitcnt vmcnt(11)
    v_lshlrev_b32 v28, 16, v20
    v_lshlrev_b32 v29, 16, v24
    v_lshlrev_b32 v30, 16, v48
    v_and_b32 v31, s34, v48
    v_fmac_f32 v96, v28, v30
    v_fmac_f32 v97, v28, v31
    v_fmac_f32 v104, v29, v30
    v_fmac_f32 v105, v29, v31
    v_lshlrev_b32 v30, 16, v49
    v_and_b32 v31, s34, v49
    v_fmac_f32 v98, v28, v30
    v_fmac_f32 v99, v28, v31
    v_fmac_f32 v106, v29, v30
    v_fmac_f32 v107, v29, v31
    v_lshlrev_b32 v30, 16, v50
    v_and_b32 v31, s34, v50
    v_fmac_f32 v100, v28, v30
    v_fmac_f32 v101, v28, v31
    v_fmac_f32 v108, v29, v30
    v_fmac_f32 v109, v29, v31
    v_lshlrev_b32 v30, 16, v51
    v_and_b32 v31, s34, v51
    v_fmac_f32 v102, v28, v30
    v_fmac_f32 v103, v28, v31
    v_fmac_f32 v110, v29, v30
    v_fmac_f32 v111, v29, v31
    s_waitcnt vmcnt(10)
    v_and_b32 v28, s34, v20
    v_and_b32 v29, s34, v24
    v_lshlrev_b32 v30, 16, v52
    v_and_b32 v31, s34, v52
    v_fmac_f32 v96, v28, v30
    v_fmac_f32 v97, v28, v31
    v_fmac_f32 v104, v29, v30
    v_fmac_f32 v105, v29, v31
    v_lshlrev_b32 v30, 16, v53
    v_and_b32 v31, s34, v53
    v_fmac_f32 v98, v28, v30
    v_fmac_f32 v99, v28, v31
    v_fmac_f32 v106, v29, v30
    v_fmac_f32 v107, v29, v31
    v_lshlrev_b32 v30, 16, v54
    v_and_b32 v31, s34, v54
    v_fmac_f32 v100, v28, v30
    v_fmac_f32 v101, v28, v31
    v_fmac_f32 v108, v29, v30
    v_fmac_f32 v109, v29, v31
    v_lshlrev_b32 v30, 16, v55
    v_and_b32 v31, s34, v55
    v_fmac_f32 v102, v28, v30
    v_fmac_f32 v103, v28, v31
    v_fmac_f32 v110, v29, v30
    v_fmac_f32 v111, v29, v31
    s_waitcnt vmcnt(9)
    v_lshlrev_b32 v28, 16, v21
    v_lshlrev_b32 v29, 16, v25
    v_lshlrev_b32 v30, 16, v56
    v_and_b32 v31, s34, v56
    v_fmac_f32 v96, v28, v30
    v_fmac_f32 v97, v28, v31
    v_fmac_f32 v104, v29, v30
    v_fmac_f32 v105, v29, v31
    v_lshlrev_b32 v30, 16, v57
    v_and_b32 v31, s34, v57
    v_fmac_f32 v98, v28, v30
    v_fmac_f32 v99, v28, v31
    v_fmac_f32 v106, v29, v30
    v_fmac_f32 v107, v29, v31
    v_lshlrev_b32 v30, 16, v58
    v_and_b32 v31, s34, v58
    v_fmac_f32 v100, v28, v30
    v_fmac_f32 v101, v28, v31
    v_fmac_f32 v108, v29, v30
    v_fmac_f32 v109, v29, v31
    v_lshlrev_b32 v30, 16, v59
    v_and_b32 v31, s34, v59
    v_fmac_f32 v102, v28, v30
    v_fmac_f32 v103, v28, v31
    v_fmac_f32 v110, v29, v30
    v_fmac_f32 v111, v29, v31
    s_waitcnt vmcnt(8)
    v_and_b32 v28, s34, v21
    v_and_b32 v29, s34, v25
    v_lshlrev_b32 v30, 16, v60
    v_and_b32 v31, s34, v60
    v_fmac_f32 v96, v28, v30
    v_fmac_f32 v97, v28, v31
    v_fmac_f32 v104, v29, v30
    v_fmac_f32 v105, v29, v31
    v_lshlrev_b32 v30, 16, v61
    v_and_b32 v31, s34, v61
    v_fmac_f32 v98, v28, v30
    v_fmac_f32 v99, v28, v31
    v_fmac_f32 v106, v29, v30
    v_fmac_f32 v107, v29, v31
    v_lshlrev_b32 v30, 16, v62
    v_and_b32 v31, s34, v62
    v_fmac_f32 v100, v28, v30
    v_fmac_f32 v101, v28, v31
    v_fmac_f32 v108, v29, v30
    v_fmac_f32 v109, v29, v31
    v_lshlrev_b32 v30, 16, v63
    v_and_b32 v31, s34, v63
    v_fmac_f32 v102, v28, v30
    v_fmac_f32 v103, v28, v31
    v_fmac_f32 v110, v29, v30
    v_fmac_f32 v111, v29, v31
    s_nop 1
    v_permlane32_swap_b32 v96, v104
    v_permlane32_swap_b32 v97, v105
    v_permlane32_swap_b32 v98, v106
    v_permlane32_swap_b32 v99, v107
    v_permlane32_swap_b32 v100, v108
    v_permlane32_swap_b32 v101, v109
    v_permlane32_swap_b32 v102, v110
    v_permlane32_swap_b32 v103, v111
    v_add_f32 v96, v96, v104
    v_add_f32 v97, v97, v105
    v_add_f32 v98, v98, v106
    v_add_f32 v99, v99, v107
    v_add_f32 v100, v100, v108
    v_add_f32 v101, v101, v109
    v_add_f32 v102, v102, v110
    v_add_f32 v103, v103, v111
    s_nop 1
    v_permlane16_swap_b32 v96, v100
    v_permlane16_swap_b32 v97, v101
    v_permlane16_swap_b32 v98, v102
    v_permlane16_swap_b32 v99, v103
    v_add_f32 v96, v96, v100
    v_add_f32 v97, v97, v101
    v_add_f32 v98, v98, v102
    v_add_f32 v99, v99, v103
    s_nop 1
    v_add_f32_dpp v96, v96, v96 row_ror:4 row_mask:0xf bank_mask:0xf
    v_add_f32_dpp v97, v97, v97 row_ror:4 row_mask:0xf bank_mask:0xf
    v_add_f32_dpp v98, v98, v98 row_ror:4 row_mask:0xf bank_mask:0xf
    v_add_f32_dpp v99, v99, v99 row_ror:4 row_mask:0xf bank_mask:0xf
    v_add_f32_dpp v96, v96, v96 row_ror:8 row_mask:0xf bank_mask:0xf
    v_add_f32_dpp v97, v97, v97 row_ror:8 row_mask:0xf bank_mask:0xf
    v_add_f32_dpp v98, v98, v98 row_ror:8 row_mask:0xf bank_mask:0xf
    v_add_f32_dpp v99, v99, v99 row_ror:8 row_mask:0xf bank_mask:0xf
    v_lshrrev_b32 v28, 5, v0
    v_lshlrev_b32 v28, 7, v28
    v_lshlrev_b32 v30, 5, v27
    v_add_u32 v28, v28, v30
    v_and_b32 v30, 16, v0
    v_add_u32 v28, v28, v30
    s_lshl_b32 s35, s3, 8
    v_add_u32 v28, s35, v28
    ds_write_b128 v28, v[96:99] offset:2048
    s_waitcnt lgkmcnt(0)
    v_mov_b32 v30, 0
    v_mov_b32 v31, 1
    s_mov_b64 exec, 1
    ds_add_u32 v30, v31 offset:8256
    s_mov_b64 exec, -1
K1_hwait:
    ds_read_b32 v31, v30 offset:8256
    s_waitcnt lgkmcnt(0)
    v_readfirstlane_b32 s35, v31
    s_cmp_ge_u32 s35, 4
    s_cbranch_scc1 K1_hdone
    s_sleep 2
    s_branch K1_hwait
K1_hdone:
    v_lshlrev_b32 v28, 2, v0
    ds_read_b32 v96, v28 offset:2048
    ds_read_b32 v97, v28 offset:2304
    ds_read_b32 v98, v28 offset:2560
    ds_read_b32 v99, v28 offset:2816
    s_waitcnt lgkmcnt(0)
    v_add_f32 v96, v96, v97
    v_add_f32 v98, v98, v99
    v_add_f32 v96, v96, v98
    v_cvt_pk_bf16_f32 v96, v96, v96
    v_lshlrev_b32 v96, 16, v96
    v_mul_f32 v97, 0xbfb8aa3b, v96
    v_exp_f32 v97, v97
    s_nop 0
    v_add_f32 v97, 1.0, v97
    v_rcp_f32 v97, v97
    s_nop 0
    v_mul_f32 v96, v96, v97
    v_cvt_pk_bf16_f32 v96, v96, v96
    v_lshlrev_b32 v96, 16, v96
    s_lshl_b32 s35, s3, 8
    v_add_u32 v28, s35, v28
    ds_write_b32 v28, v96 offset:3072
    v_lshlrev_b32 v28, 5, v10
    v_add_u32 v28, s35, v28
    s_waitcnt lgkmcnt(0)
    ds_read_b128 v[96:99], v28 offset:3072
    ds_read_b128 v[100:103], v28 offset:3088
    ds_read_b128 v[104:107], v28 offset:3200
    ds_read_b128 v[108:111], v28 offset:3216
    v_mov_b32 v112, 0
    v_mov_b32 v113, 0
    v_mov_b32 v114, 0
    v_mov_b32 v115, 0
    v_mov_b32 v116, 0
    v_mov_b32 v117, 0
    v_mov_b32 v118, 0
    v_mov_b32 v119, 0
    v_mov_b32 v120, 0
    v_mov_b32 v121, 0
    v_mov_b32 v122, 0
    v_mov_b32 v123, 0
    v_mov_b32 v124, 0
    v_mov_b32 v125, 0
    v_mov_b32 v126, 0
    v_mov_b32 v127, 0
    s_waitcnt vmcnt(0) lgkmcnt(0)
    v_lshlrev_b32 v30, 16, v64
    v_and_b32 v31, s34, v64
    v_fmac_f32 v112, v96, v30
    v_fmac_f32 v113, v96, v31
    v_fmac_f32 v120, v104, v30
    v_fmac_f32 v121, v104, v31
    v_lshlrev_b32 v30, 16, v65
    v_and_b32 v31, s34, v65
    v_fmac_f32 v114, v96, v30
    v_fmac_f32 v115, v96, v31
    v_fmac_f32 v122, v104, v30
    v_fmac_f32 v123, v104, v31
    v_lshlrev_b32 v30, 16, v66
    v_and_b32 v31, s34, v66
    v_fmac_f32 v116, v96, v30
    v_fmac_f32 v117, v96, v31
    v_fmac_f32 v124, v104, v30
    v_fmac_f32 v125, v104, v31
    v_lshlrev_b32 v30, 16, v67
    v_and_b32 v31, s34, v67
    v_fmac_f32 v118, v96, v30
    v_fmac_f32 v119, v96, v31
    v_fmac_f32 v126, v104, v30
    v_fmac_f32 v127, v104, v31
    v_lshlrev_b32 v30, 16, v68
    v_and_b32 v31, s34, v68
    v_fmac_f32 v112, v97, v30
    v_fmac_f32 v113, v97, v31
    v_fmac_f32 v120, v105, v30
    v_fmac_f32 v121, v105, v31
    v_lshlrev_b32 v30, 16, v69
    v_and_b32 v31, s34, v69
    v_fmac_f32 v114, v97, v30
    v_fmac_f32 v115, v97, v31
    v_fmac_f32 v122, v105, v30
    v_fmac_f32 v123, v105, v31
    v_lshlrev_b32 v30, 16, v70
    v_and_b32 v31, s34, v70
    v_fmac_f32 v116, v97, v30
    v_fmac_f32 v117, v97, v31
    v_fmac_f32 v124, v105, v30
    v_fmac_f32 v125, v105, v31
    v_lshlrev_b32 v30, 16, v71
    v_and_b32 v31, s34, v71
    v_fmac_f32 v118, v97, v30
    v_fmac_f32 v119, v97, v31
    v_fmac_f32 v126, v105, v30
    v_fmac_f32 v127, v105, v31
    v_lshlrev_b32 v30, 16, v72
    v_and_b32 v31, s34, v72
    v_fmac_f32 v112, v98, v30
    v_fmac_f32 v113, v98, v31
    v_fmac_f32 v120, v106, v30
    v_fmac_f32 v121, v106, v31
    v_lshlrev_b32 v30, 16, v73
    v_and_b32 v31, s34, v73
    v_fmac_f32 v114, v98, v30
    v_fmac_f32 v115, v98, v31
    v_fmac_f32 v122, v106, v30
    v_fmac_f32 v123, v106, v31
    v_lshlrev_b32 v30, 16, v74
    v_and_b32 v31, s34, v74
    v_fmac_f32 v116, v98, v30
    v_fmac_f32 v117, v98, v31
    v_fmac_f32 v124, v106, v30
    v_fmac_f32 v125, v106, v31
    v_lshlrev_b32 v30, 16, v75
    v_and_b32 v31, s34, v75
    v_fmac_f32 v118, v98, v30
    v_fmac_f32 v119, v98, v31
    v_fmac_f32 v126, v106, v30
    v_fmac_f32 v127, v106, v31
    v_lshlrev_b32 v30, 16, v76
    v_and_b32 v31, s34, v76
    v_fmac_f32 v112, v99, v30
    v_fmac_f32 v113, v99, v31
    v_fmac_f32 v120, v107, v30
    v_fmac_f32 v121, v107, v31
    v_lshlrev_b32 v30, 16, v77
    v_and_b32 v31, s34, v77
    v_fmac_f32 v114, v99, v30
    v_fmac_f32 v115, v99, v31
    v_fmac_f32 v122, v107, v30
    v_fmac_f32 v123, v107, v31
    v_lshlrev_b32 v30, 16, v78
    v_and_b32 v31, s34, v78
    v_fmac_f32 v116, v99, v30
    v_fmac_f32 v117, v99, v31
    v_fmac_f32 v124, v107, v30
    v_fmac_f32 v125, v107, v31
    v_lshlrev_b32 v30, 16, v79
    v_and_b32 v31, s34, v79
    v_fmac_f32 v118, v99, v30
    v_fmac_f32 v119, v99, v31
    v_fmac_f32 v126, v107, v30
    v_fmac_f32 v127, v107, v31
    v_lshlrev_b32 v30, 16, v80
    v_and_b32 v31, s34, v80
    v_fmac_f32 v112, v100, v30
    v_fmac_f32 v113, v100, v31
    v_fmac_f32 v120, v108, v30
    v_fmac_f32 v121, v108, v31
    v_lshlrev_b32 v30, 16, v81
    v_and_b32 v31, s34, v81
    v_fmac_f32 v114, v100, v30
    v_fmac_f32 v115, v100, v31
    v_fmac_f32 v122, v108, v30
    v_fmac_f32 v123, v108, v31
    v_lshlrev_b32 v30, 16, v82
    v_and_b32 v31, s34, v82
    v_fmac_f32 v116, v100, v30
    v_fmac_f32 v117, v100, v31
    v_fmac_f32 v124, v108, v30
    v_fmac_f32 v125, v108, v31
    v_lshlrev_b32 v30, 16, v83
    v_and_b32 v31, s34, v83
    v_fmac_f32 v118, v100, v30
    v_fmac_f32 v119, v100, v31
    v_fmac_f32 v126, v108, v30
    v_fmac_f32 v127, v108, v31
    v_lshlrev_b32 v30, 16, v84
    v_and_b32 v31, s34, v84
    v_fmac_f32 v112, v101, v30
    v_fmac_f32 v113, v101, v31
    v_fmac_f32 v120, v109, v30
    v_fmac_f32 v121, v109, v31
    v_lshlrev_b32 v30, 16, v85
    v_and_b32 v31, s34, v85
    v_fmac_f32 v114, v101, v30
    v_fmac_f32 v115, v101, v31
    v_fmac_f32 v122, v109, v30
    v_fmac_f32 v123, v109, v31
    v_lshlrev_b32 v30, 16, v86
    v_and_b32 v31, s34, v86
    v_fmac_f32 v116, v101, v30
    v_fmac_f32 v117, v101, v31
    v_fmac_f32 v124, v109, v30
    v_fmac_f32 v125, v109, v31
    v_lshlrev_b32 v30, 16, v87
    v_and_b32 v31, s34, v87
    v_fmac_f32 v118, v101, v30
    v_fmac_f32 v119, v101, v31
    v_fmac_f32 v126, v109, v30
    v_fmac_f32 v127, v109, v31
    v_lshlrev_b32 v30, 16, v88
    v_and_b32 v31, s34, v88
    v_fmac_f32 v112, v102, v30
    v_fmac_f32 v113, v102, v31
    v_fmac_f32 v120, v110, v30
    v_fmac_f32 v121, v110, v31
    v_lshlrev_b32 v30, 16, v89
    v_and_b32 v31, s34, v89
    v_fmac_f32 v114, v102, v30
    v_fmac_f32 v115, v102, v31
    v_fmac_f32 v122, v110, v30
    v_fmac_f32 v123, v110, v31
    v_lshlrev_b32 v30, 16, v90
    v_and_b32 v31, s34, v90
    v_fmac_f32 v116, v102, v30
    v_fmac_f32 v117, v102, v31
    v_fmac_f32 v124, v110, v30
    v_fmac_f32 v125, v110, v31
    v_lshlrev_b32 v30, 16, v91
    v_and_b32 v31, s34, v91
    v_fmac_f32 v118, v102, v30
    v_fmac_f32 v119, v102, v31
    v_fmac_f32 v126, v110, v30
    v_fmac_f32 v127, v110, v31
    v_lshlrev_b32 v30, 16, v92
    v_and_b32 v31, s34, v92
    v_fmac_f32 v112, v103, v30
    v_fmac_f32 v113, v103, v31
    v_fmac_f32 v120, v111, v30
    v_fmac_f32 v121, v111, v31
    v_lshlrev_b32 v30, 16, v93
    v_and_b32 v31, s34, v93
    v_fmac_f32 v114, v103, v30
    v_fmac_f32 v115, v103, v31
    v_fmac_f32 v122, v111, v30
    v_fmac_f32 v123, v111, v31
    v_lshlrev_b32 v30, 16, v94
    v_and_b32 v31, s34, v94
    v_fmac_f32 v116, v103, v30
    v_fmac_f32 v117, v103, v31
    v_fmac_f32 v124, v111, v30
    v_fmac_f32 v125, v111, v31
    v_lshlrev_b32 v30, 16, v95
    v_and_b32 v31, s34, v95
    v_fmac_f32 v118, v103, v30
    v_fmac_f32 v119, v103, v31
    v_fmac_f32 v126, v111, v30
    v_fmac_f32 v127, v111, v31
    s_nop 1
    v_permlane32_swap_b32 v112, v120
    v_permlane32_swap_b32 v113, v121
    v_permlane32_swap_b32 v114, v122
    v_permlane32_swap_b32 v115, v123
    v_permlane32_swap_b32 v116, v124
    v_permlane32_swap_b32 v117, v125
    v_permlane32_swap_b32 v118, v126
    v_permlane32_swap_b32 v119, v127
    v_add_f32 v112, v112, v120
    v_add_f32 v113, v113, v121
    v_add_f32 v114, v114, v122
    v_add_f32 v115, v115, v123
    v_add_f32 v116, v116, v124
    v_add_f32 v117, v117, v125
    v_add_f32 v118, v118, v126
    v_add_f32 v119, v119, v127
    s_nop 1
    v_permlane16_swap_b32 v112, v116
    v_permlane16_swap_b32 v113, v117
    v_permlane16_swap_b32 v114, v118
    v_permlane16_swap_b32 v115, v119
    v_add_f32 v112, v112, v116
    v_add_f32 v113, v113, v117
    v_add_f32 v114, v114, v118
    v_add_f32 v115, v115, v119
    v_lshrrev_b32 v28, 5, v0
    v_lshlrev_b32 v28, 11, v28
    v_lshlrev_b32 v30, 1, v11
    v_add_u32 v28, v28, v30
    v_and_b32 v30, 16, v0
    v_add_u32 v28, v28, v30
    s_lshl_b32 s35, s3, 9
    s_lshl_b32 s40, s59, 12
    s_add_u32 s35, s35, s40
    v_add_u32 v28, s35, v28
    s_mov_b32 s35, 1048576
    s_add_u32 s36, s46, s35
    s_addc_u32 s37, s47, 0
    s_and_b32 s37, s37, 0xffff
    s_mov_b32 s38, 229376
    s_mov_b32 s39, 0x00020000
    buffer_store_dwordx4 v[112:115], v28, s[36:39], 0 offen
K1_noffn:
    v_bfe_u32 v12, v0, 2, 2
    v_lshlrev_b32 v13, 3, v10
    v_add_u32 v12, v12, v13
    v_lshlrev_b32 v12, 8, v12
    v_and_b32 v13, 3, v0
    v_lshlrev_b32 v13, 3, v13
    v_add3_u32 v12, v12, v13, s58
    s_waitcnt vmcnt(0)
    ds_read_b64_tr_b16 v[32:33], v12 offset:0
    ds_read_b64_tr_b16 v[34:35], v12 offset:1024
    ds_read_b64_tr_b16 v[36:37], v12 offset:8192
    ds_read_b64_tr_b16 v[38:39], v12 offset:9216
    ds_read_b64_tr_b16 v[40:41], v12 offset:16384
    ds_read_b64_tr_b16 v[42:43], v12 offset:17408
    ds_read_b64_tr_b16 v[44:45], v12 offset:24576
    ds_read_b64_tr_b16 v[46:47], v12 offset:25600
    s_waitcnt lgkmcnt(0)
    ds_read_b64_tr_b16 v[48:49], v12 offset:32
    ds_read_b64_tr_b16 v[50:51], v12 offset:1056
    ds_read_b64_tr_b16 v[52:53], v12 offset:8224
    ds_read_b64_tr_b16 v[54:55], v12 offset:9248
    ds_read_b64_tr_b16 v[56:57], v12 offset:16416
    ds_read_b64_tr_b16 v[58:59], v12 offset:17440
    ds_read_b64_tr_b16 v[60:61], v12 offset:24608
    ds_read_b64_tr_b16 v[62:63], v12 offset:25632
    s_waitcnt lgkmcnt(0)
    ds_read_b64_tr_b16 v[64:65], v12 offset:64
    ds_read_b64_tr_b16 v[66:67], v12 offset:1088
    ds_read_b64_tr_b16 v[68:69], v12 offset:8256
    ds_read_b64_tr_b16 v[70:71], v12 offset:9280
    ds_read_b64_tr_b16 v[72:73], v12 offset:16448
    ds_read_b64_tr_b16 v[74:75], v12 offset:17472
    ds_read_b64_tr_b16 v[76:77], v12 offset:24640
    ds_read_b64_tr_b16 v[78:79], v12 offset:25664
    s_waitcnt lgkmcnt(0)
    ds_read_b64_tr_b16 v[80:81], v12 offset:96
    ds_read_b64_tr_b16 v[82:83], v12 offset:1120
    ds_read_b64_tr_b16 v[84:85], v12 offset:8288
    ds_read_b64_tr_b16 v[86:87], v12 offset:9312
    ds_read_b64_tr_b16 v[88:89], v12 offset:16480
    ds_read_b64_tr_b16 v[90:91], v12 offset:17504
    ds_read_b64_tr_b16 v[92:93], v12 offset:24672
    ds_read_b64_tr_b16 v[94:95], v12 offset:25696
    s_waitcnt lgkmcnt(0)
    ds_read_b64_tr_b16 v[96:97], v12 offset:128
    ds_read_b64_tr_b16 v[98:99], v12 offset:1152
    ds_read_b64_tr_b16 v[100:101], v12 offset:8320
    ds_read_b64_tr_b16 v[102:103], v12 offset:9344
    ds_read_b64_tr_b16 v[104:105], v12 offset:16512
    ds_read_b64_tr_b16 v[106:107], v12 offset:17536
    ds_read_b64_tr_b16 v[108:109], v12 offset:24704
    ds_read_b64_tr_b16 v[110:111], v12 offset:25728
    s_waitcnt lgkmcnt(0)
    ds_read_b64_tr_b16 v[112:113], v12 offset:160
    ds_read_b64_tr_b16 v[114:115], v12 offset:1184
    ds_read_b64_tr_b16 v[116:117], v12 offset:8352
    ds_read_b64_tr_b16 v[118:119], v12 offset:9376
    ds_read_b64_tr_b16 v[120:121], v12 offset:16544
    ds_read_b64_tr_b16 v[122:123], v12 offset:17568
    ds_read_b64_tr_b16 v[124:125], v12 offset:24736
    ds_read_b64_tr_b16 v[126:127], v12 offset:25760
    s_waitcnt lgkmcnt(0)
    ds_read_b64_tr_b16 v[128:129], v12 offset:192
    ds_read_b64_tr_b16 v[130:131], v12 offset:1216
    ds_read_b64_tr_b16 v[132:133], v12 offset:8384
    ds_read_b64_tr_b16 v[134:135], v12 offset:9408
    ds_read_b64_tr_b16 v[136:137], v12 offset:16576
    ds_read_b64_tr_b16 v[138:139], v12 offset:17600
    ds_read_b64_tr_b16 v[140:141], v12 offset:24768
    ds_read_b64_tr_b16 v[142:143], v12 offset:25792
    s_waitcnt lgkmcnt(0)
    ds_read_b64_tr_b16 v[144:145], v12 offset:224
    ds_read_b64_tr_b16 v[146:147], v12 offset:1248
    ds_read_b64_tr_b16 v[148:149], v12 offset:8416
    ds_read_b64_tr_b16 v[150:151], v12 offset:9440
    ds_read_b64_tr_b16 v[152:153], v12 offset:16608
    ds_read_b64_tr_b16 v[154:155], v12 offset:17632
    ds_read_b64_tr_b16 v[156:157], v12 offset:24800
    ds_read_b64_tr_b16 v[158:159], v12 offset:25824
    s_waitcnt lgkmcnt(0)
    s_mov_b32 s36, s46
    s_and_b32 s37, s47, 0xffff
    s_mov_b32 s38, 526336
    s_mov_b32 s39, 0x00020000
    v_mov_b32 v16, 0
    v_lshlrev_b32 v13, 2, v0
    s_mul_i32 s35, s3, 768
    s_add_u32 s35, s35, 8448
    v_add_u32 v14, s35, v13
    ds_write_b32 v14, v16 offset:512
    v_and_b32 v1, 15, v0
    v_min_u32 v1, 2, v1
    v_lshlrev_b32 v1, 8, v1
    v_lshlrev_b32 v16, 4, v10
    v_add3_u32 v1, v1, v16, s35
    s_lshl_b32 s35, s3, 9
    v_add_u32 v15, s35, v16
    v_and_b32 v16, 15, v0
    v_cmp_eq_u32 s[56:57], 0, v16
    v_mov_b32 v12, 0
    v_lshlrev_b32 v13, 3, v0
    v_mov_b32 v8, 0
    v_mov_b32 v9, 0
    s_lshl_b32 s35, s5, 6
    s_add_u32 s35, s35, s4
    s_lshl_b32 s35, s35, 11
    s_waitcnt lgkmcnt(0)
    s_barrier
    ds_read_b128 v[16:19], v12 offset:8192
    ds_read_b128 v[20:23], v12 offset:8208
    ds_read_b128 v[24:27], v12 offset:8224
    ds_read_b128 v[28:31], v12 offset:8240
    ds_read_b64 v[160:161], v13 offset:4096
    ds_read_b64 v[162:163], v13 offset:4608
    ds_read_b64 v[164:165], v13 offset:5120
    ds_read_b64 v[166:167], v13 offset:5632
    ds_read_b64 v[2:3], v13 offset:6144
    ds_read_b64 v[4:5], v13 offset:6656
    ds_read_b64 v[6:7], v13 offset:7168
    ds_read_b64 v[10:11], v13 offset:7680
    s_waitcnt lgkmcnt(8)
    v_max3_f32 v12, v16, v18, v20
    v_max3_f32 v12, v12, v22, v24
    v_max3_f32 v12, v12, v26, v28
    v_max_f32 v12, v12, v30
    v_sub_f32 v16, v16, v12
    v_sub_f32 v18, v18, v12
    v_sub_f32 v20, v20, v12
    v_sub_f32 v22, v22, v12
    v_sub_f32 v24, v24, v12
    v_sub_f32 v26, v26, v12
    v_sub_f32 v28, v28, v12
    v_sub_f32 v30, v30, v12
    v_exp_f32 v16, v16
    v_exp_f32 v18, v18
    v_exp_f32 v20, v20
    v_exp_f32 v22, v22
    v_exp_f32 v24, v24
    v_exp_f32 v26, v26
    v_exp_f32 v28, v28
    v_exp_f32 v30, v30
    s_waitcnt lgkmcnt(0)
    v_fmac_f32 v8, v16, v160
    v_fmac_f32 v9, v16, v161
    v_fmac_f32 v8, v18, v162
    v_fmac_f32 v9, v18, v163
    v_fmac_f32 v8, v20, v164
    v_fmac_f32 v9, v20, v165
    v_fmac_f32 v8, v22, v166
    v_fmac_f32 v9, v22, v167
    v_fmac_f32 v8, v24, v2
    v_fmac_f32 v9, v24, v3
    v_fmac_f32 v8, v26, v4
    v_fmac_f32 v9, v26, v5
    v_fmac_f32 v8, v28, v6
    v_fmac_f32 v9, v28, v7
    v_fmac_f32 v8, v30, v10
    v_fmac_f32 v9, v30, v11
    v_cvt_pk_bf16_f32 v2, v8, v9
    v_lshlrev_b32 v3, 16, v2
    v_and_b32 v4, s34, v2
    v_sub_f32 v3, v8, v3
    v_sub_f32 v4, v9, v4
    v_cvt_pk_bf16_f32 v3, v3, v4
    ds_write_b32 v14, v2
    ds_write_b32 v14, v3 offset:256
    v_mul_f32 v13, v16, v17
    v_fmac_f32 v13, v18, v19
    v_fmac_f32 v13, v20, v21
    v_fmac_f32 v13, v22, v23
    v_fmac_f32 v13, v24, v25
    v_fmac_f32 v13, v26, v27
    v_fmac_f32 v13, v28, v29
    v_fmac_f32 v13, v30, v31
    s_waitcnt lgkmcnt(0)
    ds_read_b128 v[16:19], v1 offset:0
    ds_read_b128 v[20:23], v1 offset:64
    ds_read_b128 v[24:27], v1 offset:128
    ds_read_b128 v[28:31], v1 offset:192
    s_waitcnt lgkmcnt(3)
    v_mfma_f32_16x16x32_bf16 v[160:163], v[32:35], v[16:19], 0
    s_waitcnt lgkmcnt(2)
    v_mfma_f32_16x16x32_bf16 v[160:163], v[36:39], v[20:23], v[160:163]
    s_waitcnt lgkmcnt(1)
    v_mfma_f32_16x16x32_bf16 v[160:163], v[40:43], v[24:27], v[160:163]
    s_waitcnt lgkmcnt(0)
    v_mfma_f32_16x16x32_bf16 v[160:163], v[44:47], v[28:31], v[160:163]
    v_mfma_f32_16x16x32_bf16 v[164:167], v[48:51], v[16:19], 0
    v_mfma_f32_16x16x32_bf16 v[164:167], v[52:55], v[20:23], v[164:167]
    v_mfma_f32_16x16x32_bf16 v[164:167], v[56:59], v[24:27], v[164:167]
    v_mfma_f32_16x16x32_bf16 v[164:167], v[60:63], v[28:31], v[164:167]
    v_mfma_f32_16x16x32_bf16 v[4:7], v[64:67], v[16:19], 0
    v_mfma_f32_16x16x32_bf16 v[4:7], v[68:71], v[20:23], v[4:7]
    v_mfma_f32_16x16x32_bf16 v[4:7], v[72:75], v[24:27], v[4:7]
    v_mfma_f32_16x16x32_bf16 v[4:7], v[76:79], v[28:31], v[4:7]
    v_add_f32_dpp v160, v160, v160 quad_perm:[1,0,3,2] row_mask:0xf bank_mask:0xf
    v_add_f32_dpp v161, v161, v161 quad_perm:[1,0,3,2] row_mask:0xf bank_mask:0xf
    v_add_f32_dpp v162, v162, v162 quad_perm:[1,0,3,2] row_mask:0xf bank_mask:0xf
    v_add_f32_dpp v163, v163, v163 quad_perm:[1,0,3,2] row_mask:0xf bank_mask:0xf
    s_mov_b64 exec, s[56:57]
    buffer_store_dwordx4 v[160:163], v15, s[36:39], s35 offen offset:0
    s_mov_b64 exec, -1
    v_mfma_f32_16x16x32_bf16 v[8:11], v[80:83], v[16:19], 0
    v_mfma_f32_16x16x32_bf16 v[8:11], v[84:87], v[20:23], v[8:11]
    v_mfma_f32_16x16x32_bf16 v[8:11], v[88:91], v[24:27], v[8:11]
    v_mfma_f32_16x16x32_bf16 v[8:11], v[92:95], v[28:31], v[8:11]
    v_add_f32_dpp v164, v164, v164 quad_perm:[1,0,3,2] row_mask:0xf bank_mask:0xf
    v_add_f32_dpp v165, v165, v165 quad_perm:[1,0,3,2] row_mask:0xf bank_mask:0xf
    v_add_f32_dpp v166, v166, v166 quad_perm:[1,0,3,2] row_mask:0xf bank_mask:0xf
    v_add_f32_dpp v167, v167, v167 quad_perm:[1,0,3,2] row_mask:0xf bank_mask:0xf
    s_mov_b64 exec, s[56:57]
    buffer_store_dwordx4 v[164:167], v15, s[36:39], s35 offen offset:64
    s_mov_b64 exec, -1
    v_mfma_f32_16x16x32_bf16 v[160:163], v[96:99], v[16:19], 0
    v_mfma_f32_16x16x32_bf16 v[160:163], v[100:103], v[20:23], v[160:163]
    v_mfma_f32_16x16x32_bf16 v[160:163], v[104:107], v[24:27], v[160:163]
    v_mfma_f32_16x16x32_bf16 v[160:163], v[108:111], v[28:31], v[160:163]
    v_add_f32_dpp v4, v4, v4 quad_perm:[1,0,3,2] row_mask:0xf bank_mask:0xf
    v_add_f32_dpp v5, v5, v5 quad_perm:[1,0,3,2] row_mask:0xf bank_mask:0xf
    v_add_f32_dpp v6, v6, v6 quad_perm:[1,0,3,2] row_mask:0xf bank_mask:0xf
    v_add_f32_dpp v7, v7, v7 quad_perm:[1,0,3,2] row_mask:0xf bank_mask:0xf
    s_mov_b64 exec, s[56:57]
    buffer_store_dwordx4 v[4:7], v15, s[36:39], s35 offen offset:128
    s_mov_b64 exec, -1
    v_mfma_f32_16x16x32_bf16 v[164:167], v[112:115], v[16:19], 0
    v_mfma_f32_16x16x32_bf16 v[164:167], v[116:119], v[20:23], v[164:167]
    v_mfma_f32_16x16x32_bf16 v[164:167], v[120:123], v[24:27], v[164:167]
    v_mfma_f32_16x16x32_bf16 v[164:167], v[124:127], v[28:31], v[164:167]
    v_add_f32_dpp v8, v8, v8 quad_perm:[1,0,3,2] row_mask:0xf bank_mask:0xf
    v_add_f32_dpp v9, v9, v9 quad_perm:[1,0,3,2] row_mask:0xf bank_mask:0xf
    v_add_f32_dpp v10, v10, v10 quad_perm:[1,0,3,2] row_mask:0xf bank_mask:0xf
    v_add_f32_dpp v11, v11, v11 quad_perm:[1,0,3,2] row_mask:0xf bank_mask:0xf
    s_mov_b64 exec, s[56:57]
    buffer_store_dwordx4 v[8:11], v15, s[36:39], s35 offen offset:192
    s_mov_b64 exec, -1
    v_mfma_f32_16x16x32_bf16 v[4:7], v[128:131], v[16:19], 0
    v_mfma_f32_16x16x32_bf16 v[4:7], v[132:135], v[20:23], v[4:7]
    v_mfma_f32_16x16x32_bf16 v[4:7], v[136:139], v[24:27], v[4:7]
    v_mfma_f32_16x16x32_bf16 v[4:7], v[140:143], v[28:31], v[4:7]
    v_add_f32_dpp v160, v160, v160 quad_perm:[1,0,3,2] row_mask:0xf bank_mask:0xf
    v_add_f32_dpp v161, v161, v161 quad_perm:[1,0,3,2] row_mask:0xf bank_mask:0xf
    v_add_f32_dpp v162, v162, v162 quad_perm:[1,0,3,2] row_mask:0xf bank_mask:0xf
    v_add_f32_dpp v163, v163, v163 quad_perm:[1,0,3,2] row_mask:0xf bank_mask:0xf
    s_mov_b64 exec, s[56:57]
    buffer_store_dwordx4 v[160:163], v15, s[36:39], s35 offen offset:256
    s_mov_b64 exec, -1
    v_mfma_f32_16x16x32_bf16 v[8:11], v[144:147], v[16:19], 0
    v_mfma_f32_16x16x32_bf16 v[8:11], v[148:151], v[20:23], v[8:11]
    v_mfma_f32_16x16x32_bf16 v[8:11], v[152:155], v[24:27], v[8:11]
    v_mfma_f32_16x16x32_bf16 v[8:11], v[156:159], v[28:31], v[8:11]
    v_add_f32_dpp v164, v164, v164 quad_perm:[1,0,3,2] row_mask:0xf bank_mask:0xf
    v_add_f32_dpp v165, v165, v165 quad_perm:[1,0,3,2] row_mask:0xf bank_mask:0xf
    v_add_f32_dpp v166, v166, v166 quad_perm:[1,0,3,2] row_mask:0xf bank_mask:0xf
    v_add_f32_dpp v167, v167, v167 quad_perm:[1,0,3,2] row_mask:0xf bank_mask:0xf
    s_mov_b64 exec, s[56:57]
    buffer_store_dwordx4 v[164:167], v15, s[36:39], s35 offen offset:320
    s_mov_b64 exec, -1
    s_nop 7
    v_add_f32_dpp v4, v4, v4 quad_perm:[1,0,3,2] row_mask:0xf bank_mask:0xf
    v_add_f32_dpp v5, v5, v5 quad_perm:[1,0,3,2] row_mask:0xf bank_mask:0xf
    v_add_f32_dpp v6, v6, v6 quad_perm:[1,0,3,2] row_mask:0xf bank_mask:0xf
    v_add_f32_dpp v7, v7, v7 quad_perm:[1,0,3,2] row_mask:0xf bank_mask:0xf
    s_mov_b64 exec, s[56:57]
    buffer_store_dwordx4 v[4:7], v15, s[36:39], s35 offen offset:384
    s_mov_b64 exec, -1
    s_nop 3
    v_add_f32_dpp v8, v8, v8 quad_perm:[1,0,3,2] row_mask:0xf bank_mask:0xf
    v_add_f32_dpp v9, v9, v9 quad_perm:[1,0,3,2] row_mask:0xf bank_mask:0xf
    v_add_f32_dpp v10, v10, v10 quad_perm:[1,0,3,2] row_mask:0xf bank_mask:0xf
    v_add_f32_dpp v11, v11, v11 quad_perm:[1,0,3,2] row_mask:0xf bank_mask:0xf
    s_mov_b64 exec, s[56:57]
    buffer_store_dwordx4 v[8:11], v15, s[36:39], s35 offen offset:448
    s_mov_b64 exec, -1
    s_cmp_lg_u32 s3, 0
    s_cbranch_scc1 K1_end
    s_lshl_b32 s35, s4, 2
    s_add_u32 s35, s35, s5
    s_lshl_b32 s35, s35, 3
    s_add_u32 s35, s35, 524288
    v_mov_b32 v1, s35
    v_cmp_eq_u32 vcc, 0, v0
    s_and_saveexec_b64 s[42:43], vcc
    buffer_store_dwordx2 v[12:13], v1, s[36:39], 0 offen
K1_end:
    s_endpgm
.globl k2_kernel
.p2align 8
.type k2_kernel,@function
k2_kernel:
    s_cmp_ge_u32 s2, 32
    s_cbranch_scc1 K2_end
    s_load_dwordx2 s[16:17], s[0:1], 0
    s_load_dwordx4 s[20:23], s[0:1], 64
    s_load_dwordx2 s[32:33], s[0:1], 88
    s_lshr_b32 s4, s2, 4
    s_and_b32 s5, s2, 15
    s_mov_b32 s34, 0xffff0000
    v_and_b32 v1, 7, v0
    v_lshlrev_b32 v1, 4, v1
    s_lshl_b32 s6, s5, 7
    v_add_u32 v1, s6, v1
    v_lshrrev_b32 v2, 3, v0
    v_lshlrev_b32 v6, 12, v2
    s_lshl_b32 s6, s4, 5
    v_add_u32 v2, s6, v2
    v_lshlrev_b32 v5, 11, v2
    v_add_u32 v4, v5, v1
    v_lshlrev_b32 v5, 5, v2
    s_lshl_b32 s6, s4, 11
    v_add3_u32 v6, v6, v1, s6
    v_lshlrev_b32 v7, 2, v0
    s_lshl_b32 s6, s4, 10
    s_mov_b32 s40, 524288
    s_mov_b32 s41, 131072
    s_mov_b32 s42, 262144
    s_mov_b32 s43, 393216
    s_mov_b32 s35, 1048576
    s_waitcnt lgkmcnt(0)
    s_mov_b32 s8, s32
    s_and_b32 s9, s33, 0xffff
    s_mov_b32 s10, 526336
    s_mov_b32 s11, 0x00020000
    buffer_load_dwordx4 v[8:11], v5, s[8:11], s40 offen
    buffer_load_dwordx4 v[12:15], v5, s[8:11], s40 offen offset:16
    buffer_load_dwordx4 v[16:19], v4, s[8:11], 0 offen
    buffer_load_dwordx4 v[20:23], v4, s[8:11], s41 offen
    buffer_load_dwordx4 v[32:35], v4, s[8:11], s42 offen
    buffer_load_dwordx4 v[36:39], v4, s[8:11], s43 offen
    s_add_u32 s12, s32, s35
    s_addc_u32 s13, s33, 0
    s_and_b32 s13, s13, 0xffff
    s_mov_b32 s14, 229376
    s_mov_b32 s15, 0x00020000
    buffer_load_dwordx4 v[24:27], v6, s[12:15], 0 offen
    buffer_load_dwordx4 v[40:43], v6, s[12:15], s41 offen
    s_mov_b32 s24, s16
    s_and_b32 s25, s17, 0xffff
    s_mov_b32 s26, 2048
    s_mov_b32 s27, 0x00020000
    s_mov_b32 s28, s20
    s_and_b32 s29, s21, 0xffff
    s_mov_b32 s30, 1024
    s_mov_b32 s31, 0x00020000
    buffer_load_dword v28, v7, s[24:27], s6 offen
    buffer_load_dword v29, v7, s[28:31], 0 offen
    s_mov_b32 s36, s22
    s_and_b32 s37, s23, 0xffff
    s_mov_b32 s38, 2048
    s_mov_b32 s39, 0x00020000
    s_waitcnt vmcnt(8)
    v_max3_f32 v30, v8, v10, v12
    v_max_f32 v30, v30, v14
    v_sub_f32 v8, v8, v30
    v_sub_f32 v10, v10, v30
    v_sub_f32 v12, v12, v30
    v_sub_f32 v14, v14, v30
    v_exp_f32 v8, v8
    v_exp_f32 v10, v10
    v_exp_f32 v12, v12
    v_exp_f32 v14, v14
    s_nop 0
    v_mul_f32 v30, v8, v9
    v_fmac_f32 v30, v10, v11
    v_fmac_f32 v30, v12, v13
    v_fmac_f32 v30, v14, v15
    v_rcp_f32 v30, v30
    s_nop 0
    v_mul_f32 v8, v8, v30
    v_mul_f32 v10, v10, v30
    v_mul_f32 v12, v12, v30
    v_mul_f32 v14, v14, v30
    s_waitcnt vmcnt(4)
    v_mul_f32 v16, v8, v16
    v_mul_f32 v17, v8, v17
    v_mul_f32 v18, v8, v18
    v_mul_f32 v19, v8, v19
    v_fmac_f32 v16, v10, v20
    v_fmac_f32 v17, v10, v21
    v_fmac_f32 v18, v10, v22
    v_fmac_f32 v19, v10, v23
    v_fmac_f32 v16, v12, v32
    v_fmac_f32 v17, v12, v33
    v_fmac_f32 v18, v12, v34
    v_fmac_f32 v19, v12, v35
    v_fmac_f32 v16, v14, v36
    v_fmac_f32 v17, v14, v37
    v_fmac_f32 v18, v14, v38
    v_fmac_f32 v19, v14, v39
    s_waitcnt vmcnt(2)
    v_add_f32 v24, v24, v40
    v_add_f32 v25, v25, v41
    v_add_f32 v26, v26, v42
    v_add_f32 v27, v27, v43
    s_waitcnt vmcnt(0)
    v_lshlrev_b32 v31, 16, v28
    v_lshlrev_b32 v32, 16, v29
    v_and_b32 v28, s34, v28
    v_and_b32 v29, s34, v29
    v_mul_f32 v31, v31, v32
    v_mul_f32 v28, v28, v29
    v_cvt_pk_bf16_f32 v31, v31, v31
    v_lshlrev_b32 v31, 16, v31
    v_cvt_pk_bf16_f32 v28, v28, v28
    v_lshlrev_b32 v28, 16, v28
    v_add_f32 v28, v28, v31
    s_nop 1
    v_add_f32_dpp v16, v16, v16 row_ror:8 row_mask:0xf bank_mask:0xf
    v_add_f32_dpp v17, v17, v17 row_ror:8 row_mask:0xf bank_mask:0xf
    v_add_f32_dpp v18, v18, v18 row_ror:8 row_mask:0xf bank_mask:0xf
    v_add_f32_dpp v19, v19, v19 row_ror:8 row_mask:0xf bank_mask:0xf
    v_add_f32_dpp v24, v24, v24 row_ror:8 row_mask:0xf bank_mask:0xf
    v_add_f32_dpp v25, v25, v25 row_ror:8 row_mask:0xf bank_mask:0xf
    v_add_f32_dpp v26, v26, v26 row_ror:8 row_mask:0xf bank_mask:0xf
    v_add_f32_dpp v27, v27, v27 row_ror:8 row_mask:0xf bank_mask:0xf
    v_add_f32_dpp v28, v28, v28 row_ror:8 row_mask:0xf bank_mask:0xf
    s_nop 1
    v_add_f32_dpp v28, v28, v28 quad_perm:[1,0,3,2] row_mask:0xf bank_mask:0xf
    s_nop 1
    v_add_f32_dpp v28, v28, v28 quad_perm:[2,3,0,1] row_mask:0xf bank_mask:0xf
    s_nop 1
    v_add_f32_dpp v28, v28, v28 row_ror:4 row_mask:0xf bank_mask:0xf
    s_nop 1
    v_permlane32_swap_b32 v16, v24
    v_permlane32_swap_b32 v17, v25
    v_permlane32_swap_b32 v18, v26
    v_permlane32_swap_b32 v19, v27
    v_add_f32 v16, v16, v24
    v_add_f32 v17, v17, v25
    v_add_f32 v18, v18, v26
    v_add_f32 v19, v19, v27
    s_nop 1
    v_permlane16_swap_b32 v16, v18
    v_permlane16_swap_b32 v17, v19
    v_add_f32 v16, v16, v18
    v_add_f32 v17, v17, v19
    v_mov_b32 v30, v28
    v_mov_b32 v31, v28
    s_nop 1
    v_permlane32_swap_b32 v30, v31
    v_add_f32 v28, v30, v31
    v_mov_b32 v30, v28
    v_mov_b32 v31, v28
    s_nop 1
    v_permlane16_swap_b32 v30, v31
    v_add_f32 v28, v30, v31
    v_and_b32 v1, 63, v0
    v_lshrrev_b32 v2, 6, v0
    v_lshlrev_b32 v3, 8, v2
    v_lshrrev_b32 v4, 5, v1
    v_lshlrev_b32 v4, 7, v4
    v_and_b32 v5, 7, v0
    v_lshlrev_b32 v5, 4, v5
    v_bfe_u32 v6, v0, 4, 1
    v_lshlrev_b32 v6, 3, v6
    v_add3_u32 v3, v3, v4, v5
    v_add_u32 v3, v3, v6
    ds_write_b64 v3, v[16:17]
    v_lshlrev_b32 v2, 2, v2
    ds_write_b32 v2, v28 offset:1024
    s_waitcnt lgkmcnt(0)
    s_barrier
    v_cmp_gt_u32 vcc, 32, v0
    s_and_saveexec_b64 s[44:45], vcc
    s_cbranch_execz K2_end
    v_lshlrev_b32 v1, 2, v0
    v_mov_b32 v2, 0
    ds_read_b32 v8, v1 offset:0
    ds_read_b32 v12, v1 offset:128
    ds_read_b32 v9, v1 offset:256
    ds_read_b32 v13, v1 offset:384
    ds_read_b32 v10, v1 offset:512
    ds_read_b32 v14, v1 offset:640
    ds_read_b32 v11, v1 offset:768
    ds_read_b32 v15, v1 offset:896
    ds_read_b128 v[16:19], v2 offset:1024
    s_waitcnt lgkmcnt(0)
    v_add_f32 v8, v8, v9
    v_add_f32 v10, v10, v11
    v_add_f32 v12, v12, v13
    v_add_f32 v14, v14, v15
    v_add_f32 v16, v16, v17
    v_add_f32 v18, v18, v19
    v_add_f32 v8, v8, v10
    v_add_f32 v12, v12, v14
    v_add_f32 v16, v16, v18
    v_cvt_pk_bf16_f32 v8, v8, v8
    v_lshlrev_b32 v8, 16, v8
    v_cvt_pk_bf16_f32 v12, v12, v12
    v_lshlrev_b32 v12, 16, v12
    v_cvt_pk_bf16_f32 v16, v16, v16
    v_lshlrev_b32 v16, 16, v16
    v_mul_f32 v17, 0xbfb8aa3b, v16
    v_exp_f32 v17, v17
    s_nop 0
    v_add_f32 v17, 1.0, v17
    v_rcp_f32 v17, v17
    s_nop 0
    v_cvt_pk_bf16_f32 v17, v17, v17
    v_lshlrev_b32 v17, 16, v17
    v_sub_f32 v18, 1.0, v17
    v_cvt_pk_bf16_f32 v18, v18, v18
    v_lshlrev_b32 v18, 16, v18
    v_mul_f32 v8, v17, v8
    v_mul_f32 v12, v18, v12
    v_cvt_pk_bf16_f32 v8, v8, v8
    v_lshlrev_b32 v8, 16, v8
    v_cvt_pk_bf16_f32 v12, v12, v12
    v_lshlrev_b32 v12, 16, v12
    v_add_f32 v8, v8, v12
    v_cvt_pk_bf16_f32 v8, v8, v8
    s_lshl_b32 s6, s4, 10
    s_lshl_b32 s7, s5, 6
    s_add_u32 s6, s6, s7
    v_lshlrev_b32 v1, 1, v0
    buffer_store_short v8, v1, s[36:39], s6 offen
K2_end:
    s_endpgm
.section .rodata,"a"
.p2align 6
.amdhsa_kernel k1_kernel
  .amdhsa_next_free_vgpr 168
  .amdhsa_next_free_sgpr 64
  .amdhsa_accum_offset 168
  .amdhsa_group_segment_fixed_size 0
  .amdhsa_kernarg_size 96
  .amdhsa_user_sgpr_count 2
  .amdhsa_user_sgpr_kernarg_segment_ptr 1
  .amdhsa_system_sgpr_workgroup_id_x 1
.end_amdhsa_kernel
.p2align 6
.amdhsa_kernel k2_kernel
  .amdhsa_next_free_vgpr 48
  .amdhsa_next_free_sgpr 48
  .amdhsa_accum_offset 48
  .amdhsa_group_segment_fixed_size 0
  .amdhsa_kernarg_size 96
  .amdhsa_user_sgpr_count 2
  .amdhsa_user_sgpr_kernarg_segment_ptr 1
  .amdhsa_system_sgpr_workgroup_id_x 1
.end_amdhsa_kernel
```
